```python
import torch

def _softmax(x, axis=-1):
    return torch.softmax(x, dim=axis)
def _gelu(x):
    return torch.nn.functional.gelu(x, approximate="tanh")
def _silu(x):
    return torch.nn.functional.silu(x)
def _sigmoid(x):
    return torch.sigmoid(x)
def _layernorm(x, axis=-1, eps=1e-5):
    m = x.mean(dim=axis, keepdim=True)
    v = x.var(dim=axis, keepdim=True, unbiased=False)
    return (x - m) / torch.sqrt(v + eps)
def _scatter_add(tgt, idx, src, axis=0):
    return tgt.clone().index_add_(axis, idx, src)
def _segment_sum(src, seg, n):
    out = torch.zeros((n,) + src.shape[1:], dtype=src.dtype)
    return out.index_add_(0, seg, src)
def _pad(x, pw):
    flat = tuple(v for pair in reversed(pw) for v in pair)
    return torch.nn.functional.pad(x, flat)

kernel_name = 'gated_mix__ssm_conv_h3__geglu_ffn__prompt'

def setup_inputs():

    _w = (lambda a: (lambda t: t.to(torch.bfloat16) if t.is_floating_point() else t)(torch.as_tensor(a)))
    def _A_setup():
        B, S, D = 1, 2048, 512
        ks = 4
        return {
            "q": _w((lambda *s: torch.randn(*s, dtype=torch.bfloat16) * 0.05)(B, S, D)),
            "k": _w((lambda *s: torch.randn(*s, dtype=torch.bfloat16) * 0.2)(B, S, D)),
            "v": _w((lambda *s: torch.randn(*s, dtype=torch.bfloat16) * 0.2)(B, S, D)),
            "shift_k": _w((lambda *s: torch.randn(*s, dtype=torch.bfloat16) * 0.2)(D, ks) * 0.5),
            "ssm_k": _w((lambda *s: torch.randn(*s, dtype=torch.bfloat16) * 0.8)(D, S) * (1.0 / S ** 0.5)),
            "ssm_D": _w((lambda *s: torch.randn(*s, dtype=torch.bfloat16) * 0.2)(D)),
        }
    _A_in = _A_setup()

    def _B_setup():
        B, S, D, F = 1, 2048, 512, 1376
        return {
            "x": _w((lambda *s: torch.randn(*s, dtype=torch.bfloat16) * 0.05)(B, S, D)),
            "w_gate": _w((lambda *s: torch.randn(*s, dtype=torch.bfloat16) * 0.05)(D, F)),
            "w_up": _w((lambda *s: torch.randn(*s, dtype=torch.bfloat16) * 0.05)(D, F)),
            "w_down": _w((lambda *s: torch.randn(*s, dtype=torch.bfloat16) * 0.05)(F, D)),
        }
    _B_in = _B_setup()

    return {
        "A_q": _A_in["q"],
        "A_k": _A_in["k"],
        "A_v": _A_in["v"],
        "A_shift_k": _A_in["shift_k"],
        "A_ssm_k": _A_in["ssm_k"],
        "A_ssm_D": _A_in["ssm_D"],
        "B_x": _B_in["x"],
        "B_w_gate": _B_in["w_gate"],
        "B_w_up": _B_in["w_up"],
        "B_w_down": _B_in["w_down"],
        "gate_w": _w((lambda *s: torch.randn(*s, dtype=torch.bfloat16) * 0.05)(512) * 16.0),
    }

def reference(A_q, A_k, A_v, A_shift_k, A_ssm_k, A_ssm_D, B_x, B_w_gate, B_w_up, B_w_down, gate_w):
    def _A_ref(q, k, v, shift_k, ssm_k, ssm_D):
        B, S, D = q.shape
        ks = shift_k.shape[-1]
        k_pad = _pad(k, ((0, 0), (ks - 1, 0), (0, 0)))
        k_shift = torch.zeros_like(k)
        for t in range(ks):
            k_shift = k_shift + k_pad[:, t:t + S, :] * shift_k[:, ks - 1 - t][None, None, :]
        kv = k_shift * v
        L = 2 * S
        kv_pad = _pad(kv, ((0, 0), (0, S), (0, 0)))
        kf_pad = _pad(ssm_k, ((0, 0), (0, S)))
        kv_f = (lambda x, axes=(-2,-1): torch.fft.rfft2(x.float(), dim=axes))(kv_pad[:, None, :, :], axes=(1, 2))
        kf_f = (lambda x, axes=(-2,-1): torch.fft.rfft2(x.float(), dim=axes))(kf_pad[:, None, :], axes=(1, 2))
        kf_f = (lambda x, *d: x.permute(*d))(kf_f, 1, 2, 0)
        y_f = kv_f * kf_f[None, :, :, :]
        y = (lambda x, s, axes=(-2,-1): torch.fft.irfft2(x, s=s, dim=axes).to(torch.bfloat16))(y_f, (1, L), axes=(1, 2))[:, 0, :S, :]
        y = y + kv * ssm_D[None, None, :]
        return q * y

    def _B_ref(x, w_gate, w_up, w_down):
        return (_gelu(x @ w_gate) * (x @ w_up)) @ w_down

    x = A_q
    g = _sigmoid((x * gate_w).sum(-1, keepdims=True))
    a = _A_ref(x, A_k, A_v, A_shift_k, A_ssm_k, A_ssm_D)
    b = _B_ref(x, B_w_gate, B_w_up, B_w_down)
    return g * a + (1 - g) * b
```

```asm
; @launch grid=(256,1,1) block=(512,1,1) lds=163840
.amdgcn_target "amdgcn-amd-amdhsa--gfx950"
.text
.globl gated_mix__ssm_conv_h3__geglu_ffn__prompt_kernel
.p2align 8
.type gated_mix__ssm_conv_h3__geglu_ffn__prompt_kernel,@function
gated_mix__ssm_conv_h3__geglu_ffn__prompt_kernel:
    s_cmp_ge_u32 s2, 256
    s_cbranch_scc1 L_end
    s_load_dwordx2 s[24:25], s[0:1], 56
    s_load_dwordx2 s[28:29], s[0:1], 64
    s_load_dwordx2 s[4:5], s[0:1], 0
    s_load_dwordx2 s[8:9], s[0:1], 8
    s_load_dwordx2 s[12:13], s[0:1], 16
    s_load_dwordx2 s[16:17], s[0:1], 24
    s_load_dwordx2 s[44:45], s[0:1], 104
    s_load_dwordx2 s[20:21], s[0:1], 32
    s_load_dwordx2 s[52:53], s[0:1], 40
    s_load_dwordx2 s[32:33], s[0:1], 72
    s_load_dwordx2 s[36:37], s[0:1], 80
    s_load_dwordx2 s[40:41], s[0:1], 88
    s_load_dwordx2 s[48:49], s[0:1], 104
    s_mov_b32 s6, 0x200000
    s_mov_b32 s7, 0x00020000
    s_mov_b32 s10, 0x200000
    s_mov_b32 s11, 0x00020000
    s_mov_b32 s14, 0x200000
    s_mov_b32 s15, 0x00020000
    s_mov_b32 s18, 0x1000
    s_mov_b32 s19, 0x00020000
    s_mov_b32 s22, 0x200000
    s_mov_b32 s23, 0x00020000
    s_mov_b32 s26, 0x158000
    s_mov_b32 s27, 0x00020000
    s_mov_b32 s30, 0x158000
    s_mov_b32 s31, 0x00020000
    s_mov_b32 s34, 0x158000
    s_mov_b32 s35, 0x00020000
    s_mov_b32 s38, 0x400
    s_mov_b32 s39, 0x00020000
    s_mov_b32 s42, 0x200000
    s_mov_b32 s43, 0x00020000
    s_mov_b32 s46, 0x10000000
    s_mov_b32 s47, 0x00020000
    s_mov_b32 s50, 0x10000000
    s_mov_b32 s51, 0x00020000
    s_mov_b32 s54, 0x400
    s_mov_b32 s55, 0x00020000
    v_lshrrev_b32 v13, 6, v0
    v_and_b32 v1, 63, v0
    v_readfirstlane_b32 s75, v13
    s_mov_b32 s87, s2
    s_and_b32 s62, s2, 7
    s_lshr_b32 s63, s2, 3
    s_and_b32 s64, s63, 7
    s_lshr_b32 s65, s63, 3
    s_and_b32 s66, s62, 1
    s_lshr_b32 s67, s62, 1
    s_lshl_b32 s57, s66, 3
    s_add_u32 s57, s57, s64
    s_lshl_b32 s58, s67, 2
    s_add_u32 s58, s58, s65
    s_lshl_b32 s59, s67, 3
    s_add_u32 s59, s59, s64
    s_lshl_b32 s60, s66, 2
    s_add_u32 s60, s60, s65
    s_and_b32 s56, s75, 3
    s_mov_b32 s77, 0xffff0000
    v_lshlrev_b32 v2, 4, v1
    s_lshl_b32 s81, s57, 17
    s_lshl_b32 s62, s56, 15
    s_add_u32 s81, s81, s62
    s_lshr_b32 s62, s56, 1
    s_lshl_b32 s85, s87, 1
    s_add_u32 s85, s85, s62
    s_cmp_ge_u32 s75, 4
    s_cbranch_scc1 L_loader
    v_and_b32 v13, 7, v0
    v_lshrrev_b32 v14, 3, v0
    v_lshlrev_b32 v13, 4, v13
    v_lshl_add_u32 v13, v14, 11, v13
    s_lshl_b32 s62, s59, 16
    s_lshl_b32 s63, s60, 7
    s_add_u32 s62, s62, s63
    s_sub_u32 s62, s62, 3072
    v_add_u32 v128, s62, v13
    v_add_u32 v129, 1024, v128
    v_add_u32 v130, 2048, v128
    v_add_u32 v131, 3072, v128
    v_add_u32 v132, 4096, v128
    s_waitcnt lgkmcnt(0)
    buffer_load_dwordx4 a[56:59], v128, s[8:11], 0 offen
    buffer_load_dwordx4 a[60:63], v129, s[8:11], 0 offen
    buffer_load_dwordx4 a[64:67], v130, s[8:11], 0 offen
    buffer_load_dwordx4 a[68:71], v131, s[8:11], 0 offen
    buffer_load_dwordx4 a[72:75], v132, s[8:11], 0 offen
    buffer_load_dwordx4 a[76:79], v131, s[12:15], 0 offen
    buffer_load_dwordx4 a[80:83], v132, s[12:15], 0 offen
    s_mov_b32 m0, 161280
    s_lshl_b32 s63, s60, 9
    buffer_load_dwordx4 v2, s[16:19], s63 offen lds
    v_mov_b32 v13, 0
    s_mov_b32 s62, 0xb00000
    buffer_load_dword v24, v13, s[44:47], s62 offen sc1
    s_branch L_compute
L_loader:
    s_mov_b32 s62, 0x5556
    v_add_u32 v13, 0, v1
    v_mul_u32_u24 v14, s62, v13
    v_lshrrev_b32 v14, 18, v14
    v_mul_u32_u24 v15, 12, v14
    v_sub_u32 v13, v13, v15
    v_lshlrev_b32 v13, 4, v13
    v_mul_u32_u24 v14, 2752, v14
    v_add_u32 v3, v13, v14
    v_add_u32 v13, 64, v1
    v_mul_u32_u24 v14, s62, v13
    v_lshrrev_b32 v14, 18, v14
    v_mul_u32_u24 v15, 12, v14
    v_sub_u32 v13, v13, v15
    v_lshlrev_b32 v13, 4, v13
    v_mul_u32_u24 v14, 2752, v14
    v_add_u32 v4, v13, v14
    v_subrev_u32 v4, 1024, v4
    v_add_u32 v13, 128, v1
    v_mul_u32_u24 v14, s62, v13
    v_lshrrev_b32 v14, 18, v14
    v_mul_u32_u24 v15, 12, v14
    v_sub_u32 v13, v13, v15
    v_lshlrev_b32 v13, 4, v13
    v_mul_u32_u24 v14, 2752, v14
    v_add_u32 v5, v13, v14
    v_subrev_u32 v5, 2048, v5
    s_mul_i32 s80, s58, 192
    s_mul_i32 s62, s56, 44032
    s_add_u32 s80, s80, s62
    v_lshrrev_b32 v13, 3, v1
    v_lshlrev_b32 v13, 10, v13
    v_and_b32 v14, 7, v1
    v_lshl_add_u32 v6, v14, 4, v13
    v_add_u32 v7, 7152, v6
    v_add_u32 v8, 14304, v6
    v_add_u32 v9, 21456, v6
    s_lshl_b32 s3, s58, 1
    s_add_u32 s3, s3, s57
    s_and_b32 s3, s3, 3
    s_mul_i32 s2, s56, 3072
    s_mul_i32 s82, s56, 4160
    v_lshlrev_b32 v13, 2, v1
    v_add_u32 v13, 162304, v13
    v_mov_b32 v14, 0
    s_waitcnt lgkmcnt(0)
    ds_write_b32 v13, v14
    s_cmp_eq_u32 s58, 15
    s_cbranch_scc1 L_l_g
    s_add_u32 s66, s3, 0
    s_and_b32 s66, s66, 7
    s_lshl_b32 s67, s66, 7
    s_add_u32 s67, s67, s81
    s_mul_i32 s66, s66, 176128
    s_add_u32 s66, s66, s80
    s_add_u32 m0, s82, 65792
    s_nop 0
    buffer_load_dwordx4 v6, s[4:7], s67 offen offset:0 lds
    buffer_load_dwordx4 v7, s[4:7], s67 offen offset:1040 lds
    buffer_load_dwordx4 v8, s[4:7], s67 offen offset:2080 lds
    buffer_load_dwordx4 v9, s[4:7], s67 offen offset:3120 lds
    s_add_u32 m0, s2, 41216
    s_nop 0
    buffer_load_dwordx4 v3, s[24:27], s66 offen offset:0 lds
    buffer_load_dwordx4 v4, s[24:27], s66 offen offset:1024 lds
    buffer_load_dwordx4 v5, s[24:27], s66 offen offset:2048 lds
    s_add_u32 m0, s2, 53504
    s_nop 0
    buffer_load_dwordx4 v3, s[28:31], s66 offen offset:0 lds
    buffer_load_dwordx4 v4, s[28:31], s66 offen offset:1024 lds
    buffer_load_dwordx4 v5, s[28:31], s66 offen offset:2048 lds
    s_add_u32 s66, s3, 1
    s_and_b32 s66, s66, 7
    s_lshl_b32 s67, s66, 7
    s_add_u32 s67, s67, s81
    s_mul_i32 s66, s66, 176128
    s_add_u32 s66, s66, s80
    s_add_u32 m0, s82, 107008
    s_nop 0
    buffer_load_dwordx4 v6, s[4:7], s67 offen offset:0 lds
    buffer_load_dwordx4 v7, s[4:7], s67 offen offset:1040 lds
    buffer_load_dwordx4 v8, s[4:7], s67 offen offset:2080 lds
    buffer_load_dwordx4 v9, s[4:7], s67 offen offset:3120 lds
    s_add_u32 m0, s2, 82432
    s_nop 0
    buffer_load_dwordx4 v3, s[24:27], s66 offen offset:0 lds
    buffer_load_dwordx4 v4, s[24:27], s66 offen offset:1024 lds
    buffer_load_dwordx4 v5, s[24:27], s66 offen offset:2048 lds
    s_add_u32 m0, s2, 94720
    s_nop 0
    buffer_load_dwordx4 v3, s[28:31], s66 offen offset:0 lds
    buffer_load_dwordx4 v4, s[28:31], s66 offen offset:1024 lds
    buffer_load_dwordx4 v5, s[28:31], s66 offen offset:2048 lds
    s_waitcnt vmcnt(10)
    s_waitcnt lgkmcnt(0)
    s_barrier
    s_add_u32 s66, s3, 2
    s_and_b32 s66, s66, 7
    s_lshl_b32 s67, s66, 7
    s_add_u32 s67, s67, s81
    s_mul_i32 s66, s66, 176128
    s_add_u32 s66, s66, s80
    s_add_u32 m0, s82, 24576
    s_nop 0
    buffer_load_dwordx4 v6, s[4:7], s67 offen offset:0 lds
    buffer_load_dwordx4 v7, s[4:7], s67 offen offset:1040 lds
    buffer_load_dwordx4 v8, s[4:7], s67 offen offset:2080 lds
    buffer_load_dwordx4 v9, s[4:7], s67 offen offset:3120 lds
    s_add_u32 m0, s2, 0
    s_nop 0
    buffer_load_dwordx4 v3, s[24:27], s66 offen offset:0 lds
    buffer_load_dwordx4 v4, s[24:27], s66 offen offset:1024 lds
    buffer_load_dwordx4 v5, s[24:27], s66 offen offset:2048 lds
    s_add_u32 m0, s2, 12288
    s_nop 0
    buffer_load_dwordx4 v3, s[28:31], s66 offen offset:0 lds
    buffer_load_dwordx4 v4, s[28:31], s66 offen offset:1024 lds
    buffer_load_dwordx4 v5, s[28:31], s66 offen offset:2048 lds
    v_mov_b32 v13, 0
    s_mov_b32 s62, 0xb00000
    buffer_load_dword v24, v13, s[44:47], s62 offen sc1
    s_lshl_b32 s63, s87, 2
    buffer_load_dword v25, v13, s[52:55], s63 offen
    v_and_b32 v27, 255, v0
    s_and_b32 s63, s56, 1
    s_lshl_b32 s64, s85, 12
    s_lshl_b32 s65, s63, 2
    s_add_u32 s64, s64, s65
    s_sub_u32 s64, s64, 64
    s_mov_b32 s63, 0xaaab
    v_add_u32 v13, 0, v1
    v_mul_u32_u24 v14, s63, v13
    v_lshrrev_b32 v14, 20, v14
    v_mul_u32_u24 v15, 24, v14
    v_sub_u32 v15, v13, v15
    v_lshlrev_b32 v15, 4, v15
    v_lshl_add_u32 v15, v14, 8, v15
    v_add_u32 v32, s64, v15
    v_add_u32 v35, 2048, v32
    v_add_u32 v13, 64, v1
    v_mul_u32_u24 v14, s63, v13
    v_lshrrev_b32 v14, 20, v14
    v_mul_u32_u24 v15, 24, v14
    v_sub_u32 v15, v13, v15
    v_lshlrev_b32 v15, 4, v15
    v_lshl_add_u32 v15, v14, 8, v15
    v_add_u32 v33, s64, v15
    v_add_u32 v36, 2048, v33
    v_add_u32 v13, 128, v1
    v_mul_u32_u24 v14, s63, v13
    v_lshrrev_b32 v14, 20, v14
    v_mul_u32_u24 v15, 24, v14
    v_sub_u32 v15, v13, v15
    v_lshlrev_b32 v15, 4, v15
    v_lshl_add_u32 v15, v14, 8, v15
    v_add_u32 v34, s64, v15
    v_add_u32 v37, 2048, v34
    v_lshrrev_b32 v13, 3, v1
    v_bfe_u32 v14, v1, 4, 1
    v_lshlrev_b32 v14, 2, v14
    v_and_b32 v15, 7, v1
    v_xor_b32 v15, v15, v14
    v_lshlrev_b32 v15, 4, v15
    v_lshl_add_u32 v15, v13, 10, v15
    s_lshl_b32 s62, s60, 7
    v_add_u32 v28, s62, v15
    v_add_u32 v29, 7168, v28
    v_add_u32 v30, 14336, v28
    v_add_u32 v31, 21504, v28
    s_lshl_b32 s89, s56, 12
    s_mov_b32 s63, s89
    v_lshrrev_b32 v13, 5, v1
    v_lshlrev_b32 v13, 9, v13
    v_bfe_u32 v14, v1, 2, 2
    v_lshl_add_u32 v13, v14, 7, v13
    v_bfe_u32 v14, v1, 4, 1
    v_lshl_add_u32 v13, v14, 5, v13
    v_and_b32 v14, 3, v1
    v_lshl_add_u32 v13, v14, 3, v13
    v_bfe_u32 v14, v1, 3, 1
    v_lshl_add_u32 v13, v14, 6, v13
    v_add_u32 v10, s63, v13
    v_xor_b32 v14, 64, v13
    v_add_u32 v11, s63, v14
    s_mul_i32 s62, s56, 6144
    s_add_u32 s90, s62, 0
    s_add_u32 s91, s62, 24576
    s_add_u32 s92, s62, 49152
    s_add_u32 s93, s62, 73728
    s_cmp_eq_u32 s56, 3
    s_cselect_b32 s93, 2048, s93
    s_add_u32 s94, s62, 8192
    s_add_u32 s95, s62, 32768
    s_add_u32 s96, s62, 57344
    s_add_u32 s97, s62, 0xfffff800
    s_cmp_eq_u32 s56, 0
    s_cselect_b32 s97, 81920, s97
    s_add_u32 s98, s62, 22528
    s_add_u32 s99, s62, 47104
    s_add_u32 s100, s62, 71680
    s_mul_i32 s83, s59, 176128
    v_lshrrev_b32 v13, 3, v0
    v_and_b32 v14, 7, v0
    v_lshlrev_b32 v14, 4, v14
    v_lshl_add_u32 v13, v13, 10, v14
    s_lshl_b32 s62, s59, 16
    s_lshl_b32 s63, s60, 7
    s_add_u32 s62, s62, s63
    v_add_u32 v26, s62, v13
    s_waitcnt vmcnt(12)
    s_waitcnt lgkmcnt(0)
    s_barrier
    s_add_u32 s66, s3, 3
    s_and_b32 s66, s66, 7
    s_lshl_b32 s67, s66, 7
    s_add_u32 s67, s67, s81
    s_mul_i32 s66, s66, 176128
    s_add_u32 s66, s66, s80
    s_add_u32 m0, s82, 65792
    s_nop 0
    buffer_load_dwordx4 v6, s[4:7], s67 offen offset:0 lds
    buffer_load_dwordx4 v7, s[4:7], s67 offen offset:1040 lds
    buffer_load_dwordx4 v8, s[4:7], s67 offen offset:2080 lds
    buffer_load_dwordx4 v9, s[4:7], s67 offen offset:3120 lds
    s_add_u32 m0, s2, 41216
    s_nop 0
    buffer_load_dwordx4 v3, s[24:27], s66 offen offset:0 lds
    buffer_load_dwordx4 v4, s[24:27], s66 offen offset:1024 lds
    buffer_load_dwordx4 v5, s[24:27], s66 offen offset:2048 lds
    s_add_u32 m0, s2, 53504
    s_nop 0
    buffer_load_dwordx4 v3, s[28:31], s66 offen offset:0 lds
    buffer_load_dwordx4 v4, s[28:31], s66 offen offset:1024 lds
    buffer_load_dwordx4 v5, s[28:31], s66 offen offset:2048 lds
    s_waitcnt vmcnt(12)
    s_waitcnt lgkmcnt(0)
    s_barrier
    s_add_u32 s66, s3, 4
    s_and_b32 s66, s66, 7
    s_lshl_b32 s67, s66, 7
    s_add_u32 s67, s67, s81
    s_mul_i32 s66, s66, 176128
    s_add_u32 s66, s66, s80
    s_add_u32 m0, s82, 107008
    s_nop 0
    buffer_load_dwordx4 v6, s[4:7], s67 offen offset:0 lds
    buffer_load_dwordx4 v7, s[4:7], s67 offen offset:1040 lds
    buffer_load_dwordx4 v8, s[4:7], s67 offen offset:2080 lds
    buffer_load_dwordx4 v9, s[4:7], s67 offen offset:3120 lds
    s_add_u32 m0, s2, 82432
    s_nop 0
    buffer_load_dwordx4 v3, s[24:27], s66 offen offset:0 lds
    buffer_load_dwordx4 v4, s[24:27], s66 offen offset:1024 lds
    buffer_load_dwordx4 v5, s[24:27], s66 offen offset:2048 lds
    s_add_u32 m0, s2, 94720
    s_nop 0
    buffer_load_dwordx4 v3, s[28:31], s66 offen offset:0 lds
    buffer_load_dwordx4 v4, s[28:31], s66 offen offset:1024 lds
    buffer_load_dwordx4 v5, s[28:31], s66 offen offset:2048 lds
    s_waitcnt vmcnt(20)
    v_readfirstlane_b32 s61, v24
    v_readfirstlane_b32 s62, v25
    s_nop 3
    s_add_u32 s61, s61, 0x9e3779b9
    s_lshl_b32 s64, s62, 16
    s_and_b32 s65, s62, 0xffff0000
    s_cmp_lt_u32 s56, 2
    s_cselect_b32 s88, s64, s65
    s_waitcnt vmcnt(10)
    s_waitcnt lgkmcnt(0)
    s_barrier
    s_add_u32 s66, s3, 5
    s_and_b32 s66, s66, 7
    s_lshl_b32 s67, s66, 7
    s_add_u32 s67, s67, s81
    s_mul_i32 s66, s66, 176128
    s_add_u32 s66, s66, s80
    s_add_u32 m0, s82, 24576
    s_nop 0
    buffer_load_dwordx4 v6, s[4:7], s67 offen offset:0 lds
    buffer_load_dwordx4 v7, s[4:7], s67 offen offset:1040 lds
    buffer_load_dwordx4 v8, s[4:7], s67 offen offset:2080 lds
    buffer_load_dwordx4 v9, s[4:7], s67 offen offset:3120 lds
    s_add_u32 m0, s2, 0
    s_nop 0
    buffer_load_dwordx4 v3, s[24:27], s66 offen offset:0 lds
    buffer_load_dwordx4 v4, s[24:27], s66 offen offset:1024 lds
    buffer_load_dwordx4 v5, s[24:27], s66 offen offset:2048 lds
    s_add_u32 m0, s2, 12288
    s_nop 0
    buffer_load_dwordx4 v3, s[28:31], s66 offen offset:0 lds
    buffer_load_dwordx4 v4, s[28:31], s66 offen offset:1024 lds
    buffer_load_dwordx4 v5, s[28:31], s66 offen offset:2048 lds
    s_and_b32 s62, s59, 7
    s_lshl_b32 s62, s62, 2
    s_add_u32 s62, s62, s56
    s_lshl_b32 s62, s62, 16
    s_lshl_b32 s63, s60, 7
    s_add_u32 s62, s62, s63
    v_lshlrev_b32 v14, 10, v1
    buffer_load_dword v12, v14, s[32:35], s62 offen
    s_waitcnt vmcnt(11)
    s_waitcnt lgkmcnt(0)
    s_barrier
    s_add_u32 s66, s3, 6
    s_and_b32 s66, s66, 7
    s_lshl_b32 s67, s66, 7
    s_add_u32 s67, s67, s81
    s_mul_i32 s66, s66, 176128
    s_add_u32 s66, s66, s80
    s_add_u32 m0, s82, 65792
    s_nop 0
    buffer_load_dwordx4 v6, s[4:7], s67 offen offset:0 lds
    buffer_load_dwordx4 v7, s[4:7], s67 offen offset:1040 lds
    buffer_load_dwordx4 v8, s[4:7], s67 offen offset:2080 lds
    buffer_load_dwordx4 v9, s[4:7], s67 offen offset:3120 lds
    s_add_u32 m0, s2, 41216
    s_nop 0
    buffer_load_dwordx4 v3, s[24:27], s66 offen offset:0 lds
    buffer_load_dwordx4 v4, s[24:27], s66 offen offset:1024 lds
    buffer_load_dwordx4 v5, s[24:27], s66 offen offset:2048 lds
    s_add_u32 m0, s2, 53504
    s_nop 0
    buffer_load_dwordx4 v3, s[28:31], s66 offen offset:0 lds
    buffer_load_dwordx4 v4, s[28:31], s66 offen offset:1024 lds
    buffer_load_dwordx4 v5, s[28:31], s66 offen offset:2048 lds
    s_waitcnt vmcnt(11)
    s_waitcnt lgkmcnt(0)
    s_barrier
    s_add_u32 s66, s3, 7
    s_and_b32 s66, s66, 7
    s_lshl_b32 s67, s66, 7
    s_add_u32 s67, s67, s81
    s_mul_i32 s66, s66, 176128
    s_add_u32 s66, s66, s80
    s_add_u32 m0, s82, 107008
    s_nop 0
    buffer_load_dwordx4 v6, s[4:7], s67 offen offset:0 lds
    buffer_load_dwordx4 v7, s[4:7], s67 offen offset:1040 lds
    buffer_load_dwordx4 v8, s[4:7], s67 offen offset:2080 lds
    buffer_load_dwordx4 v9, s[4:7], s67 offen offset:3120 lds
    s_add_u32 m0, s2, 82432
    s_nop 0
    buffer_load_dwordx4 v3, s[24:27], s66 offen offset:0 lds
    buffer_load_dwordx4 v4, s[24:27], s66 offen offset:1024 lds
    buffer_load_dwordx4 v5, s[24:27], s66 offen offset:2048 lds
    s_add_u32 m0, s2, 94720
    s_nop 0
    buffer_load_dwordx4 v3, s[28:31], s66 offen offset:0 lds
    buffer_load_dwordx4 v4, s[28:31], s66 offen offset:1024 lds
    buffer_load_dwordx4 v5, s[28:31], s66 offen offset:2048 lds
    s_mul_i32 s70, s56, 6208
    s_add_u32 m0, s70, 123648
    s_nop 0
    buffer_load_dwordx4 v32, s[20:23], 0 offen lds
    s_add_u32 m0, s70, 124672
    s_nop 0
    buffer_load_dwordx4 v33, s[20:23], 0 offen lds
    s_add_u32 m0, s70, 125696
    s_nop 0
    buffer_load_dwordx4 v34, s[20:23], 0 offen lds
    s_add_u32 m0, s70, 126720
    s_nop 0
    buffer_load_dwordx4 v35, s[20:23], 0 offen lds
    s_add_u32 m0, s70, 127744
    s_nop 0
    buffer_load_dwordx4 v36, s[20:23], 0 offen lds
    s_add_u32 m0, s70, 128768
    s_nop 0
    buffer_load_dwordx4 v37, s[20:23], 0 offen lds
    s_lshl_b32 s70, s85, 12
    v_mov_b32 v17, 0
    buffer_load_dword v25, v17, s[20:23], s70 offen
    s_lshr_b32 s62, s56, 1
    s_and_b32 s63, s56, 1
    v_and_b32 v13, 15, v1
    v_lshrrev_b32 v14, 4, v1
    v_lshlrev_b32 v15, 2, v14
    v_sub_u32 v15, v15, v13
    v_add_u32 v15, 63, v15
    v_mul_u32_u24 v15, 80, v15
    s_mul_i32 s64, s62, 6400
    s_mul_i32 s65, s63, 160
    s_add_u32 s64, s64, s65
    s_add_u32 s64, s64, 144640
    v_add_u32 v3, s64, v15
    v_add_u32 v13, 1, v13
    v_and_b32 v5, 1, v13
    v_lshlrev_b32 v5, 4, v5
    v_bfe_u32 v15, v13, 1, 1
    v_mul_u32_u24 v15, 6208, v15
    v_and_b32 v13, 28, v13
    v_lshl_add_u32 v15, v13, 1, v15
    v_mul_u32_u24 v14, 384, v14
    v_add_u32 v15, v15, v14
    s_mul_i32 s64, s62, 12416
    s_lshl_b32 s65, s63, 7
    s_add_u32 s64, s64, s65
    s_add_u32 s64, s64, 123648
    v_add_u32 v4, s64, v15
    v_and_b32 v19, 31, v1
    v_lshlrev_b32 v19, 4, v19
    s_lshr_b32 s72, s87, 5
    s_lshl_b32 s72, s72, 9
    s_add_u32 s72, s72, 0xb01000
    v_mov_b32 v156, 0
    v_mov_b32 v157, 0
    v_mov_b32 v158, 0
    v_mov_b32 v159, 0
    v_lshlrev_b32 v17, 4, v27
    v_add_u32 v17, 148480, v17
    v_cmp_gt_u32 vcc, 80, v27
    s_nop 0
    s_and_saveexec_b64 s[78:79], vcc
    ds_write_b128 v17, v[156:159] offset:5120
    ds_write_b128 v17, v[156:159] offset:11520
    s_mov_b64 exec, -1
    s_waitcnt vmcnt(17)
    s_waitcnt lgkmcnt(0)
    s_barrier
    s_waitcnt vmcnt(7)
    s_add_u32 s71, s56, 32
    s_lshl_b32 s62, s71, 2
    s_add_u32 s62, s62, 162304
    v_mov_b32 v13, s62
    v_mov_b32 v14, 1
    s_mov_b64 exec, 1
    ds_write_b32 v13, v14
    s_mov_b64 exec, -1
L_l_join:
    s_cmp_lg_u32 s56, 0
    s_cbranch_scc1 L_po14
    buffer_load_dwordx4 v[20:23], v19, s[44:47], s72 offen sc1
    s_waitcnt vmcnt(0)
    s_mov_b32 s86, 0
L_pc15:
    v_xor_b32 v20, s61, v20
    v_xor_b32 v21, s61, v21
    v_xor_b32 v22, s61, v22
    v_xor_b32 v23, s61, v23
    v_or3_b32 v20, v20, v21, v22
    v_or_b32 v20, v20, v23
    v_cmp_eq_u32 vcc, 0, v20
    s_nop 1
    s_cmp_eq_u64 vcc, -1
    s_cbranch_scc1 L_pd15
    s_add_u32 s86, s86, 1
    s_cmp_ge_u32 s86, 200000
    s_cbranch_scc1 L_pd15
    s_sleep 8
    buffer_load_dwordx4 v[20:23], v19, s[44:47], s72 offen sc1
    s_waitcnt vmcnt(0)
    s_branch L_pc15
L_pd15:
    v_mov_b32 v13, 162360
    v_mov_b32 v14, 1
    ds_write_b32 v13, v14
    s_branch L_pe14
L_po14:
    v_mov_b32 v17, 162360
    s_mov_b32 s86, 0
L_lw16:
    ds_read_b32 v20, v17
    s_waitcnt lgkmcnt(0)
    v_cmp_eq_u32 vcc, 1, v20
    s_nop 1
    s_cmp_eq_u64 vcc, -1
    s_cbranch_scc1 L_ld16
    s_add_u32 s86, s86, 1
    s_cmp_ge_u32 s86, 1600000
    s_cbranch_scc1 L_ld16
    s_sleep 1
    s_branch L_lw16
L_ld16:
    s_waitcnt lgkmcnt(0)
L_pe14:
    s_waitcnt lgkmcnt(0)
    v_lshlrev_b32 v152, 4, v27
    s_lshl_b32 s73, s87, 13
    s_add_u32 s73, s73, 0x600000
    s_add_u32 s74, s73, 4096
    buffer_load_dwordx4 v[144:147], v152, s[44:47], s73 offen sc1
    buffer_load_dwordx4 v[148:151], v152, s[44:47], s74 offen sc1
    s_add_u32 m0, s89, 0
    s_lshl_b32 s70, s97, 4
    buffer_load_dwordx4 v28, s[32:35], s70 offen offset:0 lds
    buffer_load_dwordx4 v29, s[32:35], s70 offen offset:1024 lds
    buffer_load_dwordx4 v30, s[32:35], s70 offen offset:2048 lds
    buffer_load_dwordx4 v31, s[32:35], s70 offen offset:3072 lds
    s_add_u32 m0, s89, 16384
    s_lshl_b32 s70, s98, 4
    buffer_load_dwordx4 v28, s[32:35], s70 offen offset:0 lds
    buffer_load_dwordx4 v29, s[32:35], s70 offen offset:1024 lds
    buffer_load_dwordx4 v30, s[32:35], s70 offen offset:2048 lds
    buffer_load_dwordx4 v31, s[32:35], s70 offen offset:3072 lds
    s_waitcnt vmcnt(10)
    s_and_b32 s70, s56, 1
    s_cmp_eq_u32 s70, 1
    s_cselect_b32 s71, 15, 99
    v_cmp_eq_u32 vcc, s71, v1
    s_mul_i32 s70, s56, 6208
    s_add_u32 s70, s70, 123648
    v_cndmask_b32 v17, 0, v25, vcc
    v_lshlrev_b32 v18, 2, v1
    v_add_u32 v18, s70, v18
    s_mov_b64 exec, 0xffff
    ds_write_b32 v18, v17
    s_mov_b64 exec, -1
    v_lshrrev_b32 v152, 2, v27
    v_mul_u32_u24 v152, 80, v152
    v_and_b32 v153, 3, v27
    v_lshl_add_u32 v152, v153, 4, v152
    v_add_u32 v152, 148480, v152
    s_waitcnt vmcnt(8)
    ds_write_b128 v152, v[144:147]
    ds_write_b128 v152, v[148:151] offset:6400
    s_waitcnt lgkmcnt(0)
    s_lshl_b32 s62, s56, 2
    s_add_u32 s62, s62, 162304
    v_mov_b32 v13, s62
    v_mov_b32 v14, 1
    s_mov_b64 exec, 1
    ds_write_b32 v13, v14
    s_mov_b64 exec, -1
    s_setprio 2
    v_mov_b32 v13, 162304
    s_mov_b32 s86, 0
L_lw17:
    ds_read_b128 v[20:23], v13
    s_waitcnt lgkmcnt(0)
    v_and_b32 v20, v20, v21
    v_and_b32 v22, v22, v23
    v_and_b32 v20, v20, v22
    v_cmp_eq_u32 vcc, 1, v20
    s_nop 1
    s_cmp_eq_u64 vcc, -1
    s_cbranch_scc1 L_ld17
    s_add_u32 s86, s86, 1
    s_cmp_ge_u32 s86, 1600000
    s_cbranch_scc1 L_ld17
    s_sleep 1
    s_branch L_lw17
L_ld17:
    s_waitcnt lgkmcnt(0)
    ds_read_b64 v[64:65], v4 offset:0
    ds_read_b64 v[66:67], v4 offset:8
    ds_read_b64 v[84:85], v4 offset:1536
    ds_read_b64 v[86:87], v4 offset:1544
    ds_read_b64 v[104:105], v4 offset:3072
    ds_read_b64 v[106:107], v4 offset:3080
    ds_read_b64 v[124:125], v4 offset:4608
    ds_read_b64 v[126:127], v4 offset:4616
    ds_read_b64 v[68:69], v4 offset:16
    ds_read_b64 v[70:71], v4 offset:24
    ds_read_b64 v[88:89], v4 offset:1552
    ds_read_b64 v[90:91], v4 offset:1560
    ds_read_b64 v[108:109], v4 offset:3088
    ds_read_b64 v[110:111], v4 offset:3096
    ds_read_b64 v[128:129], v4 offset:4624
    ds_read_b64 v[130:131], v4 offset:4632
    ds_read_b64 v[72:73], v4 offset:32
    ds_read_b64 v[74:75], v4 offset:40
    ds_read_b64 v[92:93], v4 offset:1568
    ds_read_b64 v[94:95], v4 offset:1576
    ds_read_b64 v[112:113], v4 offset:3104
    ds_read_b64 v[114:115], v4 offset:3112
    ds_read_b64 v[132:133], v4 offset:4640
    ds_read_b64 v[134:135], v4 offset:4648
    ds_read_b64 v[76:77], v4 offset:48
    ds_read_b64 v[78:79], v4 offset:56
    ds_read_b64 v[96:97], v4 offset:1584
    ds_read_b64 v[98:99], v4 offset:1592
    ds_read_b64 v[116:117], v4 offset:3120
    ds_read_b64 v[118:119], v4 offset:3128
    ds_read_b64 v[136:137], v4 offset:4656
    ds_read_b64 v[138:139], v4 offset:4664
    ds_read_b128 a[0:3], v3 offset:3840
    ds_read_b128 a[4:7], v3 offset:2560
    ds_read_b128 a[8:11], v3 offset:1280
    ds_read_b128 a[12:15], v3 offset:0
    s_waitcnt lgkmcnt(15)
    v_alignbit_b32 v64, v65, v64, v5
    v_alignbit_b32 v65, v66, v65, v5
    v_alignbit_b32 v66, v67, v66, v5
    v_alignbit_b32 v67, v68, v67, v5
    v_alignbit_b32 v84, v85, v84, v5
    v_alignbit_b32 v85, v86, v85, v5
    v_alignbit_b32 v86, v87, v86, v5
    v_alignbit_b32 v87, v88, v87, v5
    v_alignbit_b32 v104, v105, v104, v5
    v_alignbit_b32 v105, v106, v105, v5
    v_alignbit_b32 v106, v107, v106, v5
    v_alignbit_b32 v107, v108, v107, v5
    v_alignbit_b32 v124, v125, v124, v5
    v_alignbit_b32 v125, v126, v125, v5
    v_alignbit_b32 v126, v127, v126, v5
    v_alignbit_b32 v127, v128, v127, v5
    v_alignbit_b32 v68, v69, v68, v5
    v_alignbit_b32 v69, v70, v69, v5
    v_alignbit_b32 v70, v71, v70, v5
    v_alignbit_b32 v71, v72, v71, v5
    v_alignbit_b32 v88, v89, v88, v5
    v_alignbit_b32 v89, v90, v89, v5
    v_alignbit_b32 v90, v91, v90, v5
    v_alignbit_b32 v91, v92, v91, v5
    v_alignbit_b32 v108, v109, v108, v5
    v_alignbit_b32 v109, v110, v109, v5
    v_alignbit_b32 v110, v111, v110, v5
    v_alignbit_b32 v111, v112, v111, v5
    s_waitcnt lgkmcnt(13)
    v_alignbit_b32 v128, v129, v128, v5
    v_alignbit_b32 v129, v130, v129, v5
    v_alignbit_b32 v130, v131, v130, v5
    v_alignbit_b32 v131, v132, v131, v5
    s_waitcnt lgkmcnt(11)
    v_alignbit_b32 v72, v73, v72, v5
    v_alignbit_b32 v73, v74, v73, v5
    v_alignbit_b32 v74, v75, v74, v5
    v_alignbit_b32 v75, v76, v75, v5
    s_waitcnt lgkmcnt(9)
    v_alignbit_b32 v92, v93, v92, v5
    v_alignbit_b32 v93, v94, v93, v5
    v_alignbit_b32 v94, v95, v94, v5
    v_alignbit_b32 v95, v96, v95, v5
    s_waitcnt lgkmcnt(7)
    v_alignbit_b32 v112, v113, v112, v5
    v_alignbit_b32 v113, v114, v113, v5
    v_alignbit_b32 v114, v115, v114, v5
    v_alignbit_b32 v115, v116, v115, v5
    s_waitcnt lgkmcnt(5)
    v_alignbit_b32 v132, v133, v132, v5
    v_alignbit_b32 v133, v134, v133, v5
    v_alignbit_b32 v134, v135, v134, v5
    v_alignbit_b32 v135, v136, v135, v5
    s_waitcnt lgkmcnt(3)
    v_mfma_f32_16x16x32_bf16 v[32:35], v[64:67], a[0:3], 0
    ds_read_b64 v[80:81], v4 offset:64
    ds_read_b64 v[82:83], v4 offset:72
    v_mfma_f32_16x16x32_bf16 v[36:39], v[72:75], a[0:3], 0
    ds_read_b64 v[100:101], v4 offset:1600
    ds_read_b64 v[102:103], v4 offset:1608
    v_mfma_f32_16x16x32_bf16 v[40:43], v[84:87], a[0:3], 0
    ds_read_b64 v[120:121], v4 offset:3136
    ds_read_b64 v[122:123], v4 offset:3144
    v_mfma_f32_16x16x32_bf16 v[44:47], v[92:95], a[0:3], 0
    ds_read_b64 v[140:141], v4 offset:4672
    ds_read_b64 v[142:143], v4 offset:4680
    v_mfma_f32_16x16x32_bf16 v[48:51], v[104:107], a[0:3], 0
    ds_read_b128 a[16:19], v3 offset:3856
    v_mfma_f32_16x16x32_bf16 v[52:55], v[112:115], a[0:3], 0
    ds_read_b128 a[20:23], v3 offset:2576
    v_mfma_f32_16x16x32_bf16 v[56:59], v[124:127], a[0:3], 0
    ds_read_b128 a[24:27], v3 offset:1296
    v_mfma_f32_16x16x32_bf16 v[60:63], v[132:135], a[0:3], 0
    ds_read_b128 a[28:31], v3 offset:16
    s_waitcnt lgkmcnt(14)
    v_mfma_f32_16x16x32_bf16 v[40:43], v[64:67], a[4:7], v[40:43]
    v_mfma_f32_16x16x32_bf16 v[44:47], v[72:75], a[4:7], v[44:47]
    s_waitcnt vmcnt(4)
    ds_read_b64_tr_b16 a[32:33], v10 offset:0
    ds_read_b64_tr_b16 a[34:35], v10 offset:1024
    ds_read_b64_tr_b16 a[36:37], v11 offset:0
    ds_read_b64_tr_b16 a[38:39], v11 offset:1024
    ds_read_b64_tr_b16 a[40:41], v10 offset:2048
    ds_read_b64_tr_b16 a[42:43], v10 offset:3072
    ds_read_b64_tr_b16 a[44:45], v11 offset:2048
    ds_read_b64_tr_b16 a[46:47], v11 offset:3072
    s_waitcnt vmcnt(0)
    ds_read_b64_tr_b16 a[48:49], v10 offset:16384
    ds_read_b64_tr_b16 a[50:51], v10 offset:17408
    ds_read_b64_tr_b16 a[52:53], v11 offset:16384
    ds_read_b64_tr_b16 a[54:55], v11 offset:17408
    ds_read_b64_tr_b16 a[56:57], v10 offset:18432
    ds_read_b64_tr_b16 a[58:59], v10 offset:19456
    ds_read_b64_tr_b16 a[60:61], v11 offset:18432
    ds_read_b64_tr_b16 a[62:63], v11 offset:19456
    v_mfma_f32_16x16x32_bf16 v[48:51], v[84:87], a[4:7], v[48:51]
    v_mfma_f32_16x16x32_bf16 v[52:55], v[92:95], a[4:7], v[52:55]
    s_waitcnt lgkmcnt(15)
    v_alignbit_b32 v76, v77, v76, v5
    v_alignbit_b32 v77, v78, v77, v5
    v_alignbit_b32 v78, v79, v78, v5
    v_alignbit_b32 v79, v80, v79, v5
    v_mfma_f32_16x16x32_bf16 v[56:59], v[104:107], a[4:7], v[56:59]
    v_mfma_f32_16x16x32_bf16 v[60:63], v[112:115], a[4:7], v[60:63]
    v_alignbit_b32 v96, v97, v96, v5
    v_alignbit_b32 v97, v98, v97, v5
    v_alignbit_b32 v98, v99, v98, v5
    v_alignbit_b32 v99, v100, v99, v5
    v_mfma_f32_16x16x32_bf16 v[48:51], v[64:67], a[8:11], v[48:51]
    v_mfma_f32_16x16x32_bf16 v[52:55], v[72:75], a[8:11], v[52:55]
    v_alignbit_b32 v116, v117, v116, v5
    v_alignbit_b32 v117, v118, v117, v5
    v_alignbit_b32 v118, v119, v118, v5
    v_alignbit_b32 v119, v120, v119, v5
    v_mfma_f32_16x16x32_bf16 v[56:59], v[84:87], a[8:11], v[56:59]
    v_mfma_f32_16x16x32_bf16 v[60:63], v[92:95], a[8:11], v[60:63]
    v_alignbit_b32 v136, v137, v136, v5
    v_alignbit_b32 v137, v138, v137, v5
    v_alignbit_b32 v138, v139, v138, v5
    v_alignbit_b32 v139, v140, v139, v5
    v_mfma_f32_16x16x32_bf16 v[56:59], v[64:67], a[12:15], v[56:59]
    s_waitcnt lgkmcnt(0)
    s_add_u32 m0, s89, 0
    s_lshl_b32 s70, s90, 4
    buffer_load_dwordx4 v28, s[32:35], s70 offen offset:0 lds
    buffer_load_dwordx4 v29, s[32:35], s70 offen offset:1024 lds
    buffer_load_dwordx4 v30, s[32:35], s70 offen offset:2048 lds
    buffer_load_dwordx4 v31, s[32:35], s70 offen offset:3072 lds
    v_mfma_f32_16x16x32_bf16 v[60:63], v[72:75], a[12:15], v[60:63]
    v_mfma_f32_16x16x32_bf16 v[32:35], v[68:71], a[16:19], v[32:35]
    ds_read_b64 v[64:65], v4 offset:80
    ds_read_b64 v[66:67], v4 offset:88
    v_mfma_f32_16x16x32_bf16 v[36:39], v[76:79], a[16:19], v[36:39]
    ds_read_b64 v[84:85], v4 offset:1616
    ds_read_b64 v[86:87], v4 offset:1624
    s_add_u32 m0, s89, 16384
    s_lshl_b32 s70, s91, 4
    buffer_load_dwordx4 v28, s[32:35], s70 offen offset:0 lds
    buffer_load_dwordx4 v29, s[32:35], s70 offen offset:1024 lds
    buffer_load_dwordx4 v30, s[32:35], s70 offen offset:2048 lds
    buffer_load_dwordx4 v31, s[32:35], s70 offen offset:3072 lds
    v_mfma_f32_16x16x32_bf16 v[40:43], v[88:91], a[16:19], v[40:43]
    ds_read_b64 v[104:105], v4 offset:3152
    ds_read_b64 v[106:107], v4 offset:3160
    v_mfma_f32_16x16x32_bf16 v[44:47], v[96:99], a[16:19], v[44:47]
    ds_read_b64 v[124:125], v4 offset:4688
    ds_read_b64 v[126:127], v4 offset:4696
    v_mfma_f32_16x16x32_bf16 v[48:51], v[108:111], a[16:19], v[48:51]
    ds_read_b128 a[0:3], v3 offset:3872
    v_mfma_f32_16x16x32_bf16 v[52:55], v[116:119], a[16:19], v[52:55]
    ds_read_b128 a[4:7], v3 offset:2592
    v_mfma_f32_16x16x32_bf16 v[56:59], v[128:131], a[16:19], v[56:59]
    ds_read_b128 a[8:11], v3 offset:1312
    v_mfma_f32_16x16x32_bf16 v[60:63], v[136:139], a[16:19], v[60:63]
    ds_read_b128 a[12:15], v3 offset:32
    v_mfma_f32_16x16x32_bf16 v[40:43], v[68:71], a[20:23], v[40:43]
    v_mfma_f32_16x16x32_bf16 v[44:47], v[76:79], a[20:23], v[44:47]
    v_mfma_f32_16x16x32_bf16 v[48:51], v[88:91], a[20:23], v[48:51]
    v_mfma_f32_16x16x32_bf16 v[52:55], v[96:99], a[20:23], v[52:55]
    s_waitcnt lgkmcnt(5)
    v_alignbit_b32 v80, v81, v80, v5
    v_alignbit_b32 v81, v82, v81, v5
    v_alignbit_b32 v82, v83, v82, v5
    v_alignbit_b32 v83, v64, v83, v5
    v_mfma_f32_16x16x32_bf16 v[56:59], v[108:111], a[20:23], v[56:59]
    v_mfma_f32_16x16x32_bf16 v[60:63], v[116:119], a[20:23], v[60:63]
    v_alignbit_b32 v100, v101, v100, v5
    v_alignbit_b32 v101, v102, v101, v5
    v_alignbit_b32 v102, v103, v102, v5
    v_alignbit_b32 v103, v84, v103, v5
    v_mfma_f32_16x16x32_bf16 v[48:51], v[68:71], a[24:27], v[48:51]
    v_mfma_f32_16x16x32_bf16 v[52:55], v[76:79], a[24:27], v[52:55]
    v_alignbit_b32 v120, v121, v120, v5
    v_alignbit_b32 v121, v122, v121, v5
    v_alignbit_b32 v122, v123, v122, v5
    v_alignbit_b32 v123, v104, v123, v5
    v_mfma_f32_16x16x32_bf16 v[56:59], v[88:91], a[24:27], v[56:59]
    v_mfma_f32_16x16x32_bf16 v[60:63], v[96:99], a[24:27], v[60:63]
    v_alignbit_b32 v140, v141, v140, v5
    v_alignbit_b32 v141, v142, v141, v5
    v_alignbit_b32 v142, v143, v142, v5
    v_alignbit_b32 v143, v124, v143, v5
    v_mfma_f32_16x16x32_bf16 v[56:59], v[68:71], a[28:31], v[56:59]
    v_mfma_f32_16x16x32_bf16 v[60:63], v[76:79], a[28:31], v[60:63]
    s_waitcnt lgkmcnt(3)
    v_mfma_f32_16x16x32_bf16 v[32:35], v[72:75], a[0:3], v[32:35]
    ds_read_b64 v[68:69], v4 offset:96
    ds_read_b64 v[70:71], v4 offset:104
    v_mfma_f32_16x16x32_bf16 v[36:39], v[80:83], a[0:3], v[36:39]
    ds_read_b64 v[88:89], v4 offset:1632
    ds_read_b64 v[90:91], v4 offset:1640
    v_mfma_f32_16x16x32_bf16 v[40:43], v[92:95], a[0:3], v[40:43]
    ds_read_b64 v[108:109], v4 offset:3168
    ds_read_b64 v[110:111], v4 offset:3176
    v_mfma_f32_16x16x32_bf16 v[44:47], v[100:103], a[0:3], v[44:47]
    ds_read_b64 v[128:129], v4 offset:4704
    ds_read_b64 v[130:131], v4 offset:4712
    v_mfma_f32_16x16x32_bf16 v[48:51], v[112:115], a[0:3], v[48:51]
    ds_read_b128 a[16:19], v3 offset:3888
    v_mfma_f32_16x16x32_bf16 v[52:55], v[120:123], a[0:3], v[52:55]
    ds_read_b128 a[20:23], v3 offset:2608
    v_mfma_f32_16x16x32_bf16 v[56:59], v[132:135], a[0:3], v[56:59]
    ds_read_b128 a[24:27], v3 offset:1328
    v_mfma_f32_16x16x32_bf16 v[60:63], v[140:143], a[0:3], v[60:63]
    ds_read_b128 a[28:31], v3 offset:48
    s_waitcnt lgkmcnt(14)
    v_mfma_f32_16x16x32_bf16 v[40:43], v[72:75], a[4:7], v[40:43]
    v_mfma_f32_16x16x32_bf16 v[44:47], v[80:83], a[4:7], v[44:47]
    v_mov_b32 v13, 162336
    s_mov_b32 s86, 0
L_lw18:
    ds_read_b128 v[20:23], v13
    s_waitcnt lgkmcnt(0)
    v_and_b32 v20, v20, v21
    v_and_b32 v22, v22, v23
    v_and_b32 v20, v20, v22
    v_cmp_eq_u32 vcc, 1, v20
    s_nop 1
    s_cmp_eq_u64 vcc, -1
    s_cbranch_scc1 L_ld18
    s_add_u32 s86, s86, 1
    s_cmp_ge_u32 s86, 1600000
    s_cbranch_scc1 L_ld18
    s_sleep 1
    s_branch L_lw18
L_ld18:
    s_waitcnt lgkmcnt(0)
    s_add_u32 m0, s89, 32768
    s_lshl_b32 s70, s99, 4
    buffer_load_dwordx4 v28, s[32:35], s70 offen offset:0 lds
    buffer_load_dwordx4 v29, s[32:35], s70 offen offset:1024 lds
    buffer_load_dwordx4 v30, s[32:35], s70 offen offset:2048 lds
    buffer_load_dwordx4 v31, s[32:35], s70 offen offset:3072 lds
    v_mfma_f32_16x16x32_bf16 v[48:51], v[92:95], a[4:7], v[48:51]
    v_mfma_f32_16x16x32_bf16 v[52:55], v[100:103], a[4:7], v[52:55]
    v_alignbit_b32 v64, v65, v64, v5
    v_alignbit_b32 v65, v66, v65, v5
    v_alignbit_b32 v66, v67, v66, v5
    v_alignbit_b32 v67, v68, v67, v5
    v_mfma_f32_16x16x32_bf16 v[56:59], v[112:115], a[4:7], v[56:59]
    s_add_u32 m0, s89, 49152
    s_lshl_b32 s70, s100, 4
    buffer_load_dwordx4 v28, s[32:35], s70 offen offset:0 lds
    buffer_load_dwordx4 v29, s[32:35], s70 offen offset:1024 lds
    buffer_load_dwordx4 v30, s[32:35], s70 offen offset:2048 lds
    buffer_load_dwordx4 v31, s[32:35], s70 offen offset:3072 lds
    v_mfma_f32_16x16x32_bf16 v[60:63], v[120:123], a[4:7], v[60:63]
    v_alignbit_b32 v84, v85, v84, v5
    v_alignbit_b32 v85, v86, v85, v5
    v_alignbit_b32 v86, v87, v86, v5
    v_alignbit_b32 v87, v88, v87, v5
    v_mfma_f32_16x16x32_bf16 v[48:51], v[72:75], a[8:11], v[48:51]
    v_mfma_f32_16x16x32_bf16 v[52:55], v[80:83], a[8:11], v[52:55]
    v_alignbit_b32 v104, v105, v104, v5
    v_alignbit_b32 v105, v106, v105, v5
    v_alignbit_b32 v106, v107, v106, v5
    v_alignbit_b32 v107, v108, v107, v5
    s_add_u32 m0, s89, 65536
    s_lshl_b32 s70, s94, 4
    buffer_load_dwordx4 v28, s[32:35], s70 offen offset:0 lds
    buffer_load_dwordx4 v29, s[32:35], s70 offen offset:1024 lds
    buffer_load_dwordx4 v30, s[32:35], s70 offen offset:2048 lds
    buffer_load_dwordx4 v31, s[32:35], s70 offen offset:3072 lds
    v_mfma_f32_16x16x32_bf16 v[56:59], v[92:95], a[8:11], v[56:59]
    v_mfma_f32_16x16x32_bf16 v[60:63], v[100:103], a[8:11], v[60:63]
    v_alignbit_b32 v124, v125, v124, v5
    v_alignbit_b32 v125, v126, v125, v5
    v_alignbit_b32 v126, v127, v126, v5
    v_alignbit_b32 v127, v128, v127, v5
    v_mfma_f32_16x16x32_bf16 v[56:59], v[72:75], a[12:15], v[56:59]
    v_mfma_f32_16x16x32_bf16 v[60:63], v[80:83], a[12:15], v[60:63]
    v_mfma_f32_16x16x32_bf16 v[32:35], v[76:79], a[16:19], v[32:35]
    ds_read_b64 v[72:73], v4 offset:112
    ds_read_b64 v[74:75], v4 offset:120
    v_mfma_f32_16x16x32_bf16 v[36:39], v[64:67], a[16:19], v[36:39]
    ds_read_b64 v[92:93], v4 offset:1648
    ds_read_b64 v[94:95], v4 offset:1656
    v_mfma_f32_16x16x32_bf16 v[40:43], v[96:99], a[16:19], v[40:43]
    ds_read_b64 v[112:113], v4 offset:3184
    ds_read_b64 v[114:115], v4 offset:3192
    v_mfma_f32_16x16x32_bf16 v[44:47], v[84:87], a[16:19], v[44:47]
    ds_read_b64 v[132:133], v4 offset:4720
    ds_read_b64 v[134:135], v4 offset:4728
    v_mfma_f32_16x16x32_bf16 v[48:51], v[116:119], a[16:19], v[48:51]
    ds_read_b128 a[0:3], v3 offset:3920
    v_mfma_f32_16x16x32_bf16 v[52:55], v[104:107], a[16:19], v[52:55]
    ds_read_b128 a[4:7], v3 offset:2640
    v_mfma_f32_16x16x32_bf16 v[56:59], v[136:139], a[16:19], v[56:59]
    ds_read_b128 a[8:11], v3 offset:1360
    v_mfma_f32_16x16x32_bf16 v[60:63], v[124:127], a[16:19], v[60:63]
    ds_read_b128 a[12:15], v3 offset:80
    v_mfma_f32_16x16x32_bf16 v[40:43], v[76:79], a[20:23], v[40:43]
    v_mfma_f32_16x16x32_bf16 v[44:47], v[64:67], a[20:23], v[44:47]
    v_mfma_f32_16x16x32_bf16 v[48:51], v[96:99], a[20:23], v[48:51]
    v_mfma_f32_16x16x32_bf16 v[52:55], v[84:87], a[20:23], v[52:55]
    s_waitcnt lgkmcnt(5)
    v_alignbit_b32 v68, v69, v68, v5
    v_alignbit_b32 v69, v70, v69, v5
    v_alignbit_b32 v70, v71, v70, v5
    v_alignbit_b32 v71, v72, v71, v5
    v_mfma_f32_16x16x32_bf16 v[56:59], v[116:119], a[20:23], v[56:59]
    v_mfma_f32_16x16x32_bf16 v[60:63], v[104:107], a[20:23], v[60:63]
    v_alignbit_b32 v88, v89, v88, v5
    v_alignbit_b32 v89, v90, v89, v5
    v_alignbit_b32 v90, v91, v90, v5
    v_alignbit_b32 v91, v92, v91, v5
    v_mfma_f32_16x16x32_bf16 v[48:51], v[76:79], a[24:27], v[48:51]
    v_mfma_f32_16x16x32_bf16 v[52:55], v[64:67], a[24:27], v[52:55]
    v_alignbit_b32 v108, v109, v108, v5
    v_alignbit_b32 v109, v110, v109, v5
    v_alignbit_b32 v110, v111, v110, v5
    v_alignbit_b32 v111, v112, v111, v5
    v_mfma_f32_16x16x32_bf16 v[56:59], v[96:99], a[24:27], v[56:59]
    v_mfma_f32_16x16x32_bf16 v[60:63], v[84:87], a[24:27], v[60:63]
    v_alignbit_b32 v128, v129, v128, v5
    v_alignbit_b32 v129, v130, v129, v5
    v_alignbit_b32 v130, v131, v130, v5
    v_alignbit_b32 v131, v132, v131, v5
    v_mfma_f32_16x16x32_bf16 v[56:59], v[76:79], a[28:31], v[56:59]
    v_mfma_f32_16x16x32_bf16 v[60:63], v[64:67], a[28:31], v[60:63]
    s_waitcnt lgkmcnt(3)
    v_mfma_f32_16x16x32_bf16 v[32:35], v[80:83], a[0:3], v[32:35]
    ds_read_b64 v[76:77], v4 offset:128
    ds_read_b64 v[78:79], v4 offset:136
    v_mfma_f32_16x16x32_bf16 v[36:39], v[68:71], a[0:3], v[36:39]
    ds_read_b64 v[96:97], v4 offset:1664
    ds_read_b64 v[98:99], v4 offset:1672
    v_mfma_f32_16x16x32_bf16 v[40:43], v[100:103], a[0:3], v[40:43]
    ds_read_b64 v[116:117], v4 offset:3200
    ds_read_b64 v[118:119], v4 offset:3208
    v_mfma_f32_16x16x32_bf16 v[44:47], v[88:91], a[0:3], v[44:47]
    ds_read_b64 v[136:137], v4 offset:4736
    ds_read_b64 v[138:139], v4 offset:4744
    v_mfma_f32_16x16x32_bf16 v[48:51], v[120:123], a[0:3], v[48:51]
    ds_read_b128 a[16:19], v3 offset:3936
    v_mfma_f32_16x16x32_bf16 v[52:55], v[108:111], a[0:3], v[52:55]
    ds_read_b128 a[20:23], v3 offset:2656
    v_mfma_f32_16x16x32_bf16 v[56:59], v[140:143], a[0:3], v[56:59]
    ds_read_b128 a[24:27], v3 offset:1376
    v_mfma_f32_16x16x32_bf16 v[60:63], v[128:131], a[0:3], v[60:63]
    ds_read_b128 a[28:31], v3 offset:96
    s_waitcnt lgkmcnt(14)
    v_mfma_f32_16x16x32_bf16 v[40:43], v[80:83], a[4:7], v[40:43]
    v_mfma_f32_16x16x32_bf16 v[44:47], v[68:71], a[4:7], v[44:47]
    s_waitcnt vmcnt(8)
    ds_read_b64_tr_b16 a[64:65], v10 offset:32768
    ds_read_b64_tr_b16 a[66:67], v10 offset:33792
    ds_read_b64_tr_b16 a[68:69], v11 offset:32768
    ds_read_b64_tr_b16 a[70:71], v11 offset:33792
    ds_read_b64_tr_b16 a[72:73], v10 offset:34816
    ds_read_b64_tr_b16 a[74:75], v10 offset:35840
    ds_read_b64_tr_b16 a[76:77], v11 offset:34816
    ds_read_b64_tr_b16 a[78:79], v11 offset:35840
    s_waitcnt vmcnt(4)
    ds_read_b64_tr_b16 a[80:81], v10 offset:49152
    ds_read_b64_tr_b16 a[82:83], v10 offset:50176
    ds_read_b64_tr_b16 a[84:85], v11 offset:49152
    ds_read_b64_tr_b16 a[86:87], v11 offset:50176
    ds_read_b64_tr_b16 a[88:89], v10 offset:51200
    ds_read_b64_tr_b16 a[90:91], v10 offset:52224
    ds_read_b64_tr_b16 a[92:93], v11 offset:51200
    ds_read_b64_tr_b16 a[94:95], v11 offset:52224
    v_mfma_f32_16x16x32_bf16 v[48:51], v[100:103], a[4:7], v[48:51]
    v_mfma_f32_16x16x32_bf16 v[52:55], v[88:91], a[4:7], v[52:55]
    s_waitcnt lgkmcnt(15)
    v_alignbit_b32 v72, v73, v72, v5
    v_alignbit_b32 v73, v74, v73, v5
    v_alignbit_b32 v74, v75, v74, v5
    v_alignbit_b32 v75, v76, v75, v5
    v_mfma_f32_16x16x32_bf16 v[56:59], v[120:123], a[4:7], v[56:59]
    v_mfma_f32_16x16x32_bf16 v[60:63], v[108:111], a[4:7], v[60:63]
    v_alignbit_b32 v92, v93, v92, v5
    v_alignbit_b32 v93, v94, v93, v5
    v_alignbit_b32 v94, v95, v94, v5
    v_alignbit_b32 v95, v96, v95, v5
    v_mfma_f32_16x16x32_bf16 v[48:51], v[80:83], a[8:11], v[48:51]
    v_mfma_f32_16x16x32_bf16 v[52:55], v[68:71], a[8:11], v[52:55]
    v_alignbit_b32 v112, v113, v112, v5
    v_alignbit_b32 v113, v114, v113, v5
    v_alignbit_b32 v114, v115, v114, v5
    v_alignbit_b32 v115, v116, v115, v5
    s_waitcnt lgkmcnt(0)
    s_add_u32 m0, s89, 32768
    s_lshl_b32 s70, s92, 4
    buffer_load_dwordx4 v28, s[32:35], s70 offen offset:0 lds
    buffer_load_dwordx4 v29, s[32:35], s70 offen offset:1024 lds
    buffer_load_dwordx4 v30, s[32:35], s70 offen offset:2048 lds
    buffer_load_dwordx4 v31, s[32:35], s70 offen offset:3072 lds
    v_mfma_f32_16x16x32_bf16 v[56:59], v[100:103], a[8:11], v[56:59]
    v_mfma_f32_16x16x32_bf16 v[60:63], v[88:91], a[8:11], v[60:63]
    v_alignbit_b32 v132, v133, v132, v5
    v_alignbit_b32 v133, v134, v133, v5
    v_alignbit_b32 v134, v135, v134, v5
    v_alignbit_b32 v135, v136, v135, v5
    v_mfma_f32_16x16x32_bf16 v[56:59], v[80:83], a[12:15], v[56:59]
    s_add_u32 m0, s89, 49152
    s_lshl_b32 s70, s93, 4
    buffer_load_dwordx4 v28, s[32:35], s70 offen offset:0 lds
    buffer_load_dwordx4 v29, s[32:35], s70 offen offset:1024 lds
    buffer_load_dwordx4 v30, s[32:35], s70 offen offset:2048 lds
    buffer_load_dwordx4 v31, s[32:35], s70 offen offset:3072 lds
    v_mfma_f32_16x16x32_bf16 v[60:63], v[68:71], a[12:15], v[60:63]
    v_mfma_f32_16x16x32_bf16 v[32:35], v[64:67], a[16:19], v[32:35]
    ds_read_b64 v[80:81], v4 offset:144
    ds_read_b64 v[82:83], v4 offset:152
    v_mfma_f32_16x16x32_bf16 v[36:39], v[72:75], a[16:19], v[36:39]
    ds_read_b64 v[100:101], v4 offset:1680
    ds_read_b64 v[102:103], v4 offset:1688
    v_mfma_f32_16x16x32_bf16 v[40:43], v[84:87], a[16:19], v[40:43]
    ds_read_b64 v[120:121], v4 offset:3216
    ds_read_b64 v[122:123], v4 offset:3224
    v_mfma_f32_16x16x32_bf16 v[44:47], v[92:95], a[16:19], v[44:47]
    ds_read_b64 v[140:141], v4 offset:4752
    ds_read_b64 v[142:143], v4 offset:4760
    v_mfma_f32_16x16x32_bf16 v[48:51], v[104:107], a[16:19], v[48:51]
    ds_read_b128 a[0:3], v3 offset:3952
    v_mfma_f32_16x16x32_bf16 v[52:55], v[112:115], a[16:19], v[52:55]
    ds_read_b128 a[4:7], v3 offset:2672
    v_mfma_f32_16x16x32_bf16 v[56:59], v[124:127], a[16:19], v[56:59]
    ds_read_b128 a[8:11], v3 offset:1392
    v_mfma_f32_16x16x32_bf16 v[60:63], v[132:135], a[16:19], v[60:63]
    ds_read_b128 a[12:15], v3 offset:112
    v_mfma_f32_16x16x32_bf16 v[40:43], v[64:67], a[20:23], v[40:43]
    v_mfma_f32_16x16x32_bf16 v[44:47], v[72:75], a[20:23], v[44:47]
    v_mfma_f32_16x16x32_bf16 v[48:51], v[84:87], a[20:23], v[48:51]
    v_mfma_f32_16x16x32_bf16 v[52:55], v[92:95], a[20:23], v[52:55]
    s_waitcnt lgkmcnt(5)
    v_alignbit_b32 v76, v77, v76, v5
    v_alignbit_b32 v77, v78, v77, v5
    v_alignbit_b32 v78, v79, v78, v5
    v_alignbit_b32 v79, v80, v79, v5
    v_mfma_f32_16x16x32_bf16 v[56:59], v[104:107], a[20:23], v[56:59]
    v_mfma_f32_16x16x32_bf16 v[60:63], v[112:115], a[20:23], v[60:63]
    v_alignbit_b32 v96, v97, v96, v5
    v_alignbit_b32 v97, v98, v97, v5
    v_alignbit_b32 v98, v99, v98, v5
    v_alignbit_b32 v99, v100, v99, v5
    v_mfma_f32_16x16x32_bf16 v[48:51], v[64:67], a[24:27], v[48:51]
    v_mfma_f32_16x16x32_bf16 v[52:55], v[72:75], a[24:27], v[52:55]
    v_alignbit_b32 v116, v117, v116, v5
    v_alignbit_b32 v117, v118, v117, v5
    v_alignbit_b32 v118, v119, v118, v5
    v_alignbit_b32 v119, v120, v119, v5
    v_mfma_f32_16x16x32_bf16 v[56:59], v[84:87], a[24:27], v[56:59]
    v_mfma_f32_16x16x32_bf16 v[60:63], v[92:95], a[24:27], v[60:63]
    v_alignbit_b32 v136, v137, v136, v5
    v_alignbit_b32 v137, v138, v137, v5
    v_alignbit_b32 v138, v139, v138, v5
    v_alignbit_b32 v139, v140, v139, v5
    v_mfma_f32_16x16x32_bf16 v[56:59], v[64:67], a[28:31], v[56:59]
    v_mfma_f32_16x16x32_bf16 v[60:63], v[72:75], a[28:31], v[60:63]
    s_waitcnt lgkmcnt(3)
    v_mfma_f32_16x16x32_bf16 v[32:35], v[68:71], a[0:3], v[32:35]
    ds_read_b64 v[64:65], v4 offset:160
    ds_read_b64 v[66:67], v4 offset:168
    v_mfma_f32_16x16x32_bf16 v[36:39], v[76:79], a[0:3], v[36:39]
    ds_read_b64 v[84:85], v4 offset:1696
    ds_read_b64 v[86:87], v4 offset:1704
    v_mfma_f32_16x16x32_bf16 v[40:43], v[88:91], a[0:3], v[40:43]
    ds_read_b64 v[104:105], v4 offset:3232
    ds_read_b64 v[106:107], v4 offset:3240
    v_mfma_f32_16x16x32_bf16 v[44:47], v[96:99], a[0:3], v[44:47]
    ds_read_b64 v[124:125], v4 offset:4768
    ds_read_b64 v[126:127], v4 offset:4776
    v_mfma_f32_16x16x32_bf16 v[48:51], v[108:111], a[0:3], v[48:51]
    ds_read_b128 a[16:19], v3 offset:3968
    v_mfma_f32_16x16x32_bf16 v[52:55], v[116:119], a[0:3], v[52:55]
    ds_read_b128 a[20:23], v3 offset:2688
    v_mfma_f32_16x16x32_bf16 v[56:59], v[128:131], a[0:3], v[56:59]
    ds_read_b128 a[24:27], v3 offset:1408
    v_mfma_f32_16x16x32_bf16 v[60:63], v[136:139], a[0:3], v[60:63]
    ds_read_b128 a[28:31], v3 offset:128
    s_waitcnt lgkmcnt(14)
    v_mfma_f32_16x16x32_bf16 v[40:43], v[68:71], a[4:7], v[40:43]
    v_mfma_f32_16x16x32_bf16 v[44:47], v[76:79], a[4:7], v[44:47]
    v_mfma_f32_16x16x32_bf16 v[48:51], v[88:91], a[4:7], v[48:51]
    s_waitcnt vmcnt(0)
    s_add_u32 s71, s56, 24
    s_lshl_b32 s62, s71, 2
    s_add_u32 s62, s62, 162304
    v_mov_b32 v13, s62
    v_mov_b32 v14, 1
    s_mov_b64 exec, 1
    ds_write_b32 v13, v14
    s_mov_b64 exec, -1
    v_mfma_f32_16x16x32_bf16 v[52:55], v[96:99], a[4:7], v[52:55]
    s_waitcnt lgkmcnt(6)
    v_alignbit_b32 v80, v81, v80, v5
    v_alignbit_b32 v81, v82, v81, v5
    v_alignbit_b32 v82, v83, v82, v5
    v_alignbit_b32 v83, v64, v83, v5
    v_mfma_f32_16x16x32_bf16 v[56:59], v[108:111], a[4:7], v[56:59]
    v_mfma_f32_16x16x32_bf16 v[60:63], v[116:119], a[4:7], v[60:63]
    v_alignbit_b32 v100, v101, v100, v5
    v_alignbit_b32 v101, v102, v101, v5
    v_alignbit_b32 v102, v103, v102, v5
    v_alignbit_b32 v103, v84, v103, v5
    v_mfma_f32_16x16x32_bf16 v[48:51], v[68:71], a[8:11], v[48:51]
    v_mfma_f32_16x16x32_bf16 v[52:55], v[76:79], a[8:11], v[52:55]
    v_alignbit_b32 v120, v121, v120, v5
    v_alignbit_b32 v121, v122, v121, v5
    v_alignbit_b32 v122, v123, v122, v5
    v_alignbit_b32 v123, v104, v123, v5
    v_mfma_f32_16x16x32_bf16 v[56:59], v[88:91], a[8:11], v[56:59]
    v_mfma_f32_16x16x32_bf16 v[60:63], v[96:99], a[8:11], v[60:63]
    v_alignbit_b32 v140, v141, v140, v5
    v_alignbit_b32 v141, v142, v141, v5
    v_alignbit_b32 v142, v143, v142, v5
    v_alignbit_b32 v143, v124, v143, v5
    v_mfma_f32_16x16x32_bf16 v[56:59], v[68:71], a[12:15], v[56:59]
    v_mfma_f32_16x16x32_bf16 v[60:63], v[76:79], a[12:15], v[60:63]
    s_waitcnt lgkmcnt(4)
    v_mfma_f32_16x16x32_bf16 v[32:35], v[72:75], a[16:19], v[32:35]
    v_mfma_f32_16x16x32_bf16 v[36:39], v[80:83], a[16:19], v[36:39]
    v_mfma_f32_16x16x32_bf16 v[40:43], v[92:95], a[16:19], v[40:43]
    v_mfma_f32_16x16x32_bf16 v[44:47], v[100:103], a[16:19], v[44:47]
    v_mfma_f32_16x16x32_bf16 v[48:51], v[112:115], a[16:19], v[48:51]
    v_mfma_f32_16x16x32_bf16 v[52:55], v[120:123], a[16:19], v[52:55]
    v_mfma_f32_16x16x32_bf16 v[56:59], v[132:135], a[16:19], v[56:59]
    v_mfma_f32_16x16x32_bf16 v[60:63], v[140:143], a[16:19], v[60:63]
    s_waitcnt lgkmcnt(3)
    v_mfma_f32_16x16x32_bf16 v[40:43], v[72:75], a[20:23], v[40:43]
    v_mfma_f32_16x16x32_bf16 v[44:47], v[80:83], a[20:23], v[44:47]
    v_mfma_f32_16x16x32_bf16 v[48:51], v[92:95], a[20:23], v[48:51]
    v_mfma_f32_16x16x32_bf16 v[52:55], v[100:103], a[20:23], v[52:55]
    v_mfma_f32_16x16x32_bf16 v[56:59], v[112:115], a[20:23], v[56:59]
    v_mfma_f32_16x16x32_bf16 v[60:63], v[120:123], a[20:23], v[60:63]
    s_waitcnt lgkmcnt(2)
    v_mfma_f32_16x16x32_bf16 v[48:51], v[72:75], a[24:27], v[48:51]
    v_mfma_f32_16x16x32_bf16 v[52:55], v[80:83], a[24:27], v[52:55]
    v_mfma_f32_16x16x32_bf16 v[56:59], v[92:95], a[24:27], v[56:59]
    v_mfma_f32_16x16x32_bf16 v[60:63], v[100:103], a[24:27], v[60:63]
    s_waitcnt lgkmcnt(1)
    v_mfma_f32_16x16x32_bf16 v[56:59], v[72:75], a[28:31], v[56:59]
    v_mfma_f32_16x16x32_bf16 v[60:63], v[80:83], a[28:31], v[60:63]
    v_mov_b32 v13, 162336
    s_mov_b32 s86, 0
L_lw19:
    ds_read_b128 v[20:23], v13
    s_waitcnt lgkmcnt(0)
    v_and_b32 v20, v20, v21
    v_and_b32 v22, v22, v23
    v_and_b32 v20, v20, v22
    v_cmp_eq_u32 vcc, 1, v20
    s_nop 1
    s_cmp_eq_u64 vcc, -1
    s_cbranch_scc1 L_ld19
    s_add_u32 s86, s86, 1
    s_cmp_ge_u32 s86, 1600000
    s_cbranch_scc1 L_ld19
    s_sleep 1
    s_branch L_lw19
L_ld19:
    s_waitcnt lgkmcnt(0)
    s_xor_b32 s64, s56, 1
    s_lshl_b32 s70, s56, 12
    s_add_u32 s70, s70, 98816
    s_lshl_b32 s63, s64, 12
    s_add_u32 s63, s63, 98816
    v_add_u32 v144, s70, v2
    v_add_u32 v145, s63, v2
    s_and_b32 s65, s56, 1
    v_and_b32 v146, 15, v1
    v_sub_u32 v147, 47, v146
    v_mul_u32_u24 v147, 80, v147
    v_lshrrev_b32 v17, 4, v1
    v_lshlrev_b32 v18, 3, v17
    v_sub_u32 v147, v147, v18
    s_lshr_b32 s66, s56, 1
    s_mul_i32 s66, s66, 6400
    s_mul_i32 s67, s65, 2560
    s_sub_u32 s66, s66, s67
    s_add_u32 s66, s66, 148504
    v_add_u32 v147, s66, v147
    v_lshlrev_b32 v146, 6, v146
    v_add_u32 v146, v146, v18
    v_add_u32 v146, s70, v146
    s_lshl_b32 s66, s85, 12
    s_lshl_b32 s67, s65, 11
    s_add_u32 s66, s66, s67
    s_add_u32 s66, s66, 0x800000
    s_cmp_eq_u32 s65, 0
    s_cbranch_scc1 L_cv_noswap
    v_swap_b32 v32, v48
    v_swap_b32 v33, v49
    v_swap_b32 v34, v50
    v_swap_b32 v35, v51
    v_swap_b32 v36, v52
    v_swap_b32 v37, v53
    v_swap_b32 v38, v54
    v_swap_b32 v39, v55
    v_swap_b32 v40, v56
    v_swap_b32 v41, v57
    v_swap_b32 v42, v58
    v_swap_b32 v43, v59
    v_swap_b32 v44, v60
    v_swap_b32 v45, v61
    v_swap_b32 v46, v62
    v_swap_b32 v47, v63
L_cv_noswap:
    s_nop 7
    ds_write_b128 v145, v[48:51] offset:0
    ds_write_b128 v145, v[52:55] offset:1024
    ds_write_b128 v145, v[56:59] offset:2048
    ds_write_b128 v145, v[60:63] offset:3072
    ds_read_b64 v[80:81], v147 offset:1312
    ds_read_b64 v[82:83], v147 offset:1280
    ds_read_b64 v[84:85], v147 offset:32
    ds_read_b64 v[86:87], v147 offset:0
    s_waitcnt lgkmcnt(4)
    s_add_u32 s71, s64, 4
    s_lshl_b32 s62, s71, 2
    s_add_u32 s62, s62, 162304
    v_mov_b32 v13, s62
    v_mov_b32 v14, 1
    s_mov_b64 exec, 1
    ds_write_b32 v13, v14
    s_mov_b64 exec, -1
    s_add_u32 s71, s56, 4
    s_lshl_b32 s62, s71, 2
    s_add_u32 s62, s62, 162304
    v_mov_b32 v17, s62
    s_mov_b32 s86, 0
L_lw20:
    ds_read_b32 v20, v17
    s_waitcnt lgkmcnt(0)
    v_cmp_eq_u32 vcc, 1, v20
    s_nop 1
    s_cmp_eq_u64 vcc, -1
    s_cbranch_scc1 L_ld20
    s_add_u32 s86, s86, 1
    s_cmp_ge_u32 s86, 1600000
    s_cbranch_scc1 L_ld20
    s_branch L_lw20
L_ld20:
    s_waitcnt lgkmcnt(0)
    ds_read_b128 v[64:67], v144 offset:0
    ds_read_b128 v[68:71], v144 offset:1024
    ds_read_b128 v[72:75], v144 offset:2048
    ds_read_b128 v[76:79], v144 offset:3072
    s_waitcnt lgkmcnt(3)
    v_add_f32 v32, v32, v64
    v_add_f32 v33, v33, v65
    v_add_f32 v34, v34, v66
    v_add_f32 v35, v35, v67
    v_cvt_pk_bf16_f32 v92, v32, v33
    v_lshlrev_b32 v32, 16, v92
    v_and_b32 v33, s77, v92
    v_cvt_pk_bf16_f32 v93, v34, v35
    v_lshlrev_b32 v34, 16, v93
    v_and_b32 v35, s77, v93
    v_and_b32 v88, s77, v81
    v_lshlrev_b32 v89, 16, v81
    v_and_b32 v90, s77, v80
    v_lshlrev_b32 v91, 16, v80
    v_mul_f32 v88, s88, v88
    v_mul_f32 v89, s88, v89
    v_mul_f32 v90, s88, v90
    v_mul_f32 v91, s88, v91
    v_cvt_pk_bf16_f32 v92, v88, v89
    v_lshlrev_b32 v88, 16, v92
    v_and_b32 v89, s77, v92
    v_cvt_pk_bf16_f32 v93, v90, v91
    v_lshlrev_b32 v90, 16, v93
    v_and_b32 v91, s77, v93
    v_add_f32 v32, v32, v88
    v_add_f32 v33, v33, v89
    v_add_f32 v34, v34, v90
    v_add_f32 v35, v35, v91
    v_cvt_pk_bf16_f32 v48, v32, v33
    v_cvt_pk_bf16_f32 v49, v34, v35
    s_waitcnt lgkmcnt(2)
    v_add_f32 v36, v36, v68
    v_add_f32 v37, v37, v69
    v_add_f32 v38, v38, v70
    v_add_f32 v39, v39, v71
    v_cvt_pk_bf16_f32 v92, v36, v37
    v_lshlrev_b32 v36, 16, v92
    v_and_b32 v37, s77, v92
    v_cvt_pk_bf16_f32 v93, v38, v39
    v_lshlrev_b32 v38, 16, v93
    v_and_b32 v39, s77, v93
    v_and_b32 v88, s77, v83
    v_lshlrev_b32 v89, 16, v83
    v_and_b32 v90, s77, v82
    v_lshlrev_b32 v91, 16, v82
    v_mul_f32 v88, s88, v88
    v_mul_f32 v89, s88, v89
    v_mul_f32 v90, s88, v90
    v_mul_f32 v91, s88, v91
    v_cvt_pk_bf16_f32 v92, v88, v89
    v_lshlrev_b32 v88, 16, v92
    v_and_b32 v89, s77, v92
    v_cvt_pk_bf16_f32 v93, v90, v91
    v_lshlrev_b32 v90, 16, v93
    v_and_b32 v91, s77, v93
    v_add_f32 v36, v36, v88
    v_add_f32 v37, v37, v89
    v_add_f32 v38, v38, v90
    v_add_f32 v39, v39, v91
    v_cvt_pk_bf16_f32 v50, v36, v37
    v_cvt_pk_bf16_f32 v51, v38, v39
    s_waitcnt lgkmcnt(1)
    v_add_f32 v40, v40, v72
    v_add_f32 v41, v41, v73
    v_add_f32 v42, v42, v74
    v_add_f32 v43, v43, v75
    v_cvt_pk_bf16_f32 v92, v40, v41
    v_lshlrev_b32 v40, 16, v92
    v_and_b32 v41, s77, v92
    v_cvt_pk_bf16_f32 v93, v42, v43
    v_lshlrev_b32 v42, 16, v93
    v_and_b32 v43, s77, v93
    v_and_b32 v88, s77, v85
    v_lshlrev_b32 v89, 16, v85
    v_and_b32 v90, s77, v84
    v_lshlrev_b32 v91, 16, v84
    v_mul_f32 v88, s88, v88
    v_mul_f32 v89, s88, v89
    v_mul_f32 v90, s88, v90
    v_mul_f32 v91, s88, v91
    v_cvt_pk_bf16_f32 v92, v88, v89
    v_lshlrev_b32 v88, 16, v92
    v_and_b32 v89, s77, v92
    v_cvt_pk_bf16_f32 v93, v90, v91
    v_lshlrev_b32 v90, 16, v93
    v_and_b32 v91, s77, v93
    v_add_f32 v40, v40, v88
    v_add_f32 v41, v41, v89
    v_add_f32 v42, v42, v90
    v_add_f32 v43, v43, v91
    v_cvt_pk_bf16_f32 v52, v40, v41
    v_cvt_pk_bf16_f32 v53, v42, v43
    s_waitcnt lgkmcnt(0)
    v_add_f32 v44, v44, v76
    v_add_f32 v45, v45, v77
    v_add_f32 v46, v46, v78
    v_add_f32 v47, v47, v79
    v_cvt_pk_bf16_f32 v92, v44, v45
    v_lshlrev_b32 v44, 16, v92
    v_and_b32 v45, s77, v92
    v_cvt_pk_bf16_f32 v93, v46, v47
    v_lshlrev_b32 v46, 16, v93
    v_and_b32 v47, s77, v93
    v_and_b32 v88, s77, v87
    v_lshlrev_b32 v89, 16, v87
    v_and_b32 v90, s77, v86
    v_lshlrev_b32 v91, 16, v86
    v_mul_f32 v88, s88, v88
    v_mul_f32 v89, s88, v89
    v_mul_f32 v90, s88, v90
    v_mul_f32 v91, s88, v91
    v_cvt_pk_bf16_f32 v92, v88, v89
    v_lshlrev_b32 v88, 16, v92
    v_and_b32 v89, s77, v92
    v_cvt_pk_bf16_f32 v93, v90, v91
    v_lshlrev_b32 v90, 16, v93
    v_and_b32 v91, s77, v93
    v_add_f32 v44, v44, v88
    v_add_f32 v45, v45, v89
    v_add_f32 v46, v46, v90
    v_add_f32 v47, v47, v91
    v_cvt_pk_bf16_f32 v54, v44, v45
    v_cvt_pk_bf16_f32 v55, v46, v47
    ds_write_b64 v146, v[48:49] offset:0
    ds_write_b64 v146, v[50:51] offset:32
    ds_write_b64 v146, v[52:53] offset:1024
    ds_write_b64 v146, v[54:55] offset:1056
    ds_read_b128 v[64:67], v144
    ds_read_b128 v[68:71], v144 offset:1024
    s_waitcnt lgkmcnt(0)
    buffer_store_dwordx4 v[64:67], v2, s[44:47], s66 offen sc1
    buffer_store_dwordx4 v[68:71], v2, s[44:47], s66 offen offset:1024 sc1
    s_waitcnt lgkmcnt(0)
    s_add_u32 s71, s56, 28
    s_lshl_b32 s62, s71, 2
    s_add_u32 s62, s62, 162304
    v_mov_b32 v13, s62
    v_mov_b32 v14, 1
    s_mov_b64 exec, 1
    ds_write_b32 v13, v14
    s_mov_b64 exec, -1
    s_waitcnt vmcnt(0)
    s_lshl_b32 s62, s87, 4
    s_lshl_b32 s63, s56, 2
    s_add_u32 s62, s62, s63
    s_add_u32 s62, s62, 0xb08000
    v_mov_b32 v13, s61
    v_mov_b32 v14, 0
    s_mov_b64 exec, 1
    buffer_store_dword v13, v14, s[44:47], s62 offen sc1
    s_mov_b64 exec, -1
    s_setprio 0
    v_mov_b32 v17, 162352
    s_mov_b32 s86, 0
L_lw21:
    ds_read_b32 v20, v17
    s_waitcnt lgkmcnt(0)
    v_cmp_eq_u32 vcc, 1, v20
    s_nop 1
    s_cmp_eq_u64 vcc, -1
    s_cbranch_scc1 L_ld21
    s_add_u32 s86, s86, 1
    s_cmp_ge_u32 s86, 1600000
    s_cbranch_scc1 L_ld21
    s_sleep 1
    s_branch L_lw21
L_ld21:
    s_waitcnt lgkmcnt(0)
    v_mov_b32 v17, 162368
    s_mov_b32 s86, 0
L_lw22:
    ds_read_b32 v20, v17
    s_waitcnt lgkmcnt(0)
    v_cmp_eq_u32 vcc, 1, v20
    s_nop 1
    s_cmp_eq_u64 vcc, -1
    s_cbranch_scc1 L_ld22
    s_add_u32 s86, s86, 1
    s_cmp_ge_u32 s86, 1600000
    s_cbranch_scc1 L_ld22
    s_sleep 1
    s_branch L_lw22
L_ld22:
    s_waitcnt lgkmcnt(0)
    v_and_b32 v19, 7, v1
    v_lshlrev_b32 v19, 4, v19
    s_lshl_b32 s75, s59, 9
    s_add_u32 s75, s75, 0xb02100
    s_cmp_lg_u32 s56, 0
    s_cbranch_scc1 L_po23
    buffer_load_dwordx4 v[20:23], v19, s[44:47], s75 offen sc1
    s_waitcnt vmcnt(0)
    s_mov_b32 s86, 0
L_pc24:
    v_xor_b32 v20, s61, v20
    v_xor_b32 v21, s61, v21
    v_xor_b32 v22, s61, v22
    v_xor_b32 v23, s61, v23
    v_or3_b32 v20, v20, v21, v22
    v_or_b32 v20, v20, v23
    v_cmp_eq_u32 vcc, 0, v20
    s_nop 1
    s_cmp_eq_u64 vcc, -1
    s_cbranch_scc1 L_pd24
    s_add_u32 s86, s86, 1
    s_cmp_ge_u32 s86, 200000
    s_cbranch_scc1 L_pd24
    s_sleep 4
    buffer_load_dwordx4 v[20:23], v19, s[44:47], s75 offen sc1
    s_waitcnt vmcnt(0)
    s_branch L_pc24
L_pd24:
    v_mov_b32 v13, 162356
    v_mov_b32 v14, 1
    ds_write_b32 v13, v14
    s_branch L_pe23
L_po23:
    v_mov_b32 v17, 162356
    s_mov_b32 s86, 0
L_lw25:
    ds_read_b32 v20, v17
    s_waitcnt lgkmcnt(0)
    v_cmp_eq_u32 vcc, 1, v20
    s_nop 1
    s_cmp_eq_u64 vcc, -1
    s_cbranch_scc1 L_ld25
    s_add_u32 s86, s86, 1
    s_cmp_ge_u32 s86, 1600000
    s_cbranch_scc1 L_ld25
    s_sleep 1
    s_branch L_lw25
L_ld25:
    s_waitcnt lgkmcnt(0)
L_pe23:
    s_waitcnt lgkmcnt(0)
    s_add_u32 s71, s83, s97
    buffer_load_dwordx4 v[96:99], v2, s[44:47], s71 offen offset:0 sc1
    buffer_load_dwordx4 v[100:103], v2, s[44:47], s71 offen offset:1024 sc1
    s_add_u32 s71, s83, s97
    s_add_u32 s71, s71, 88064
    buffer_load_dwordx4 v[104:107], v2, s[44:47], s71 offen offset:0 sc1
    buffer_load_dwordx4 v[108:111], v2, s[44:47], s71 offen offset:1024 sc1
    s_add_u32 s71, s83, s98
    buffer_load_dwordx4 v[112:115], v2, s[44:47], s71 offen offset:0 sc1
    buffer_load_dwordx4 v[116:119], v2, s[44:47], s71 offen offset:1024 sc1
    s_add_u32 s71, s83, s98
    s_add_u32 s71, s71, 88064
    buffer_load_dwordx4 v[120:123], v2, s[44:47], s71 offen offset:0 sc1
    buffer_load_dwordx4 v[124:127], v2, s[44:47], s71 offen offset:1024 sc1
    s_add_u32 s71, s83, s99
    buffer_load_dwordx4 v[128:131], v2, s[44:47], s71 offen offset:0 sc1
    buffer_load_dwordx4 v[132:135], v2, s[44:47], s71 offen offset:1024 sc1
    s_add_u32 s71, s83, s99
    s_add_u32 s71, s71, 88064
    buffer_load_dwordx4 v[136:139], v2, s[44:47], s71 offen offset:0 sc1
    buffer_load_dwordx4 v[140:143], v2, s[44:47], s71 offen offset:1024 sc1
    s_add_u32 s71, s83, s100
    s_cmp_eq_u32 s56, 3
    s_cselect_b32 s71, 0x10000000, s71
    buffer_load_dwordx4 v[144:147], v2, s[44:47], s71 offen offset:0 sc1
    buffer_load_dwordx4 v[148:151], v2, s[44:47], s71 offen offset:1024 sc1
    s_add_u32 s71, s83, s100
    s_add_u32 s71, s71, 88064
    s_cmp_eq_u32 s56, 3
    s_cselect_b32 s71, 0x10000000, s71
    buffer_load_dwordx4 v[152:155], v2, s[44:47], s71 offen offset:0 sc1
    buffer_load_dwordx4 v[156:159], v2, s[44:47], s71 offen offset:1024 sc1
    v_lshrrev_b32 v13, 3, v0
    v_lshlrev_b32 v13, 2, v13
    s_lshl_b32 s62, s59, 8
    s_add_u32 s62, s62, 0xa00000
    buffer_load_dwordx4 v[28:31], v26, s[4:7], 0 offen
    s_waitcnt vmcnt(16)
    v_mfma_f32_32x32x16_bf16 v[32:47], a[32:35], v[96:99], 0
    v_mfma_f32_32x32x16_bf16 v[64:79], a[36:39], v[96:99], 0
    s_waitcnt vmcnt(14)
    v_mfma_f32_32x32x16_bf16 v[48:63], a[32:35], v[104:107], 0
    v_mfma_f32_32x32x16_bf16 v[80:95], a[36:39], v[104:107], 0
    v_mfma_f32_32x32x16_bf16 v[32:47], a[40:43], v[100:103], v[32:47]
    v_mfma_f32_32x32x16_bf16 v[64:79], a[44:47], v[100:103], v[64:79]
    s_waitcnt vmcnt(13)
    v_mfma_f32_32x32x16_bf16 v[48:63], a[40:43], v[108:111], v[48:63]
    v_mfma_f32_32x32x16_bf16 v[80:95], a[44:47], v[108:111], v[80:95]
    s_waitcnt vmcnt(12)
    v_mfma_f32_32x32x16_bf16 v[32:47], a[48:51], v[112:115], v[32:47]
    v_mfma_f32_32x32x16_bf16 v[64:79], a[52:55], v[112:115], v[64:79]
    s_waitcnt vmcnt(10)
    v_mfma_f32_32x32x16_bf16 v[48:63], a[48:51], v[120:123], v[48:63]
    v_mfma_f32_32x32x16_bf16 v[80:95], a[52:55], v[120:123], v[80:95]
    v_mfma_f32_32x32x16_bf16 v[32:47], a[56:59], v[116:119], v[32:47]
    v_mfma_f32_32x32x16_bf16 v[64:79], a[60:63], v[116:119], v[64:79]
    s_waitcnt vmcnt(9)
    v_mfma_f32_32x32x16_bf16 v[48:63], a[56:59], v[124:127], v[48:63]
    v_mfma_f32_32x32x16_bf16 v[80:95], a[60:63], v[124:127], v[80:95]
    s_waitcnt vmcnt(8)
    v_mfma_f32_32x32x16_bf16 v[32:47], a[64:67], v[128:131], v[32:47]
    v_mfma_f32_32x32x16_bf16 v[64:79], a[68:71], v[128:131], v[64:79]
    s_waitcnt vmcnt(6)
    v_mfma_f32_32x32x16_bf16 v[48:63], a[64:67], v[136:139], v[48:63]
    v_mfma_f32_32x32x16_bf16 v[80:95], a[68:71], v[136:139], v[80:95]
    v_mfma_f32_32x32x16_bf16 v[32:47], a[72:75], v[132:135], v[32:47]
    v_mfma_f32_32x32x16_bf16 v[64:79], a[76:79], v[132:135], v[64:79]
    s_waitcnt vmcnt(5)
    v_mfma_f32_32x32x16_bf16 v[48:63], a[72:75], v[140:143], v[48:63]
    v_mfma_f32_32x32x16_bf16 v[80:95], a[76:79], v[140:143], v[80:95]
    s_waitcnt vmcnt(4)
    v_mfma_f32_32x32x16_bf16 v[32:47], a[80:83], v[144:147], v[32:47]
    v_mfma_f32_32x32x16_bf16 v[64:79], a[84:87], v[144:147], v[64:79]
    s_waitcnt vmcnt(2)
    v_mfma_f32_32x32x16_bf16 v[48:63], a[80:83], v[152:155], v[48:63]
    v_mfma_f32_32x32x16_bf16 v[80:95], a[84:87], v[152:155], v[80:95]
    v_mfma_f32_32x32x16_bf16 v[32:47], a[88:91], v[148:151], v[32:47]
    v_mfma_f32_32x32x16_bf16 v[64:79], a[92:95], v[148:151], v[64:79]
    s_waitcnt vmcnt(1)
    v_mfma_f32_32x32x16_bf16 v[48:63], a[88:91], v[156:159], v[48:63]
    v_mfma_f32_32x32x16_bf16 v[80:95], a[92:95], v[156:159], v[80:95]
    v_mov_b32 v13, 162416
    s_mov_b32 s86, 0
L_lw26:
    ds_read_b128 v[20:23], v13
    s_waitcnt lgkmcnt(0)
    v_and_b32 v20, v20, v21
    v_and_b32 v22, v22, v23
    v_and_b32 v20, v20, v22
    v_cmp_eq_u32 vcc, 1, v20
    s_nop 1
    s_cmp_eq_u64 vcc, -1
    s_cbranch_scc1 L_ld26
    s_add_u32 s86, s86, 1
    s_cmp_ge_u32 s86, 1600000
    s_cbranch_scc1 L_ld26
    s_sleep 1
    s_branch L_lw26
L_ld26:
    s_waitcnt lgkmcnt(0)
    s_mul_i32 s71, s56, 17408
    s_add_u32 s71, s71, 82432
    v_and_b32 v13, 31, v1
    v_mul_u32_u24 v13, 272, v13
    v_lshrrev_b32 v14, 5, v1
    v_lshl_add_u32 v13, v14, 4, v13
    v_add_u32 v13, s71, v13
    s_nop 7
    ds_write_b128 v13, v[32:35] offset:0
    ds_write_b128 v13, v[36:39] offset:32
    ds_write_b128 v13, v[40:43] offset:64
    ds_write_b128 v13, v[44:47] offset:96
    ds_write_b128 v13, v[48:51] offset:8704
    ds_write_b128 v13, v[52:55] offset:8736
    ds_write_b128 v13, v[56:59] offset:8768
    ds_write_b128 v13, v[60:63] offset:8800
    ds_write_b128 v13, v[64:67] offset:128
    ds_write_b128 v13, v[68:71] offset:160
    ds_write_b128 v13, v[72:75] offset:192
    ds_write_b128 v13, v[76:79] offset:224
    ds_write_b128 v13, v[80:83] offset:8832
    ds_write_b128 v13, v[84:87] offset:8864
    ds_write_b128 v13, v[88:91] offset:8896
    ds_write_b128 v13, v[92:95] offset:8928
    v_lshrrev_b32 v14, 3, v0
    v_and_b32 v16, 7, v0
    v_mul_u32_u24 v13, 272, v14
    v_lshl_add_u32 v13, v16, 5, v13
    v_add_u32 v17, 82432, v13
    v_lshrrev_b32 v15, 6, v0
    v_xor_b32 v15, v15, v16
    v_lshlrev_b32 v15, 4, v15
    v_lshl_add_u32 v15, v16, 10, v15
    v_lshlrev_b32 v18, 2, v14
    v_add_u32 v18, 162816, v18
    v_and_b32 v14, 7, v14
    v_lshl_add_u32 v15, v14, 1, v15
    v_add_u32 v15, 152064, v15
    s_waitcnt lgkmcnt(0)
    v_mov_b32 v96, 0
    v_mov_b32 v97, 0
    v_mov_b32 v98, 0
    v_mov_b32 v99, 0
    v_mov_b32 v100, 0
    v_mov_b32 v101, 0
    v_mov_b32 v102, 0
    v_mov_b32 v103, 0
    s_barrier
    ds_read_b32 v12, v18
    ds_read_b128 v[32:35], v13 offset:0
    ds_read_b128 v[36:39], v13 offset:16
    ds_read_b128 v[40:43], v13 offset:17408
    ds_read_b128 v[44:47], v13 offset:17424
    ds_read_b128 v[48:51], v13 offset:34816
    ds_read_b128 v[52:55], v13 offset:34832
    ds_read_b128 v[56:59], v13 offset:52224
    ds_read_b128 v[60:63], v13 offset:52240
    ds_read_b128 v[64:67], v17 offset:0
    ds_read_b128 v[68:71], v17 offset:16
    ds_read_b128 v[72:75], v17 offset:17408
    ds_read_b128 v[76:79], v17 offset:17424
    ds_read_b128 v[80:83], v17 offset:34816
    ds_read_b128 v[84:87], v17 offset:34832
    ds_read_b128 v[88:91], v17 offset:52224
    ds_read_b128 v[92:95], v17 offset:52240
    ds_read_u16_d16_hi v96, v15 offset:0
    ds_read_u16_d16_hi v97, v15 offset:128
    ds_read_u16_d16_hi v98, v15 offset:256
    ds_read_u16_d16_hi v99, v15 offset:384
    ds_read_u16_d16_hi v100, v15 offset:512
    ds_read_u16_d16_hi v101, v15 offset:640
    ds_read_u16_d16_hi v102, v15 offset:768
    ds_read_u16_d16_hi v103, v15 offset:896
    s_waitcnt vmcnt(0) lgkmcnt(15)
    v_lshlrev_b32 v104, 16, v12
    v_and_b32 v105, s77, v12
    v_lshlrev_b32 v112, 16, v28
    v_and_b32 v113, s77, v28
    v_lshlrev_b32 v114, 16, v29
    v_and_b32 v115, s77, v29
    v_lshlrev_b32 v116, 16, v30
    v_and_b32 v117, s77, v30
    v_lshlrev_b32 v118, 16, v31
    v_and_b32 v119, s77, v31
    v_add_f32 v32, v32, v40
    v_add_f32 v33, v33, v41
    v_add_f32 v34, v34, v42
    v_add_f32 v35, v35, v43
    v_add_f32 v36, v36, v44
    v_add_f32 v37, v37, v45
    v_add_f32 v38, v38, v46
    v_add_f32 v39, v39, v47
    v_add_f32 v48, v48, v56
    v_add_f32 v49, v49, v57
    v_add_f32 v50, v50, v58
    v_add_f32 v51, v51, v59
    v_add_f32 v52, v52, v60
    v_add_f32 v53, v53, v61
    v_add_f32 v54, v54, v62
    v_add_f32 v55, v55, v63
    s_waitcnt lgkmcnt(12)
    v_add_f32 v64, v64, v72
    v_add_f32 v65, v65, v73
    v_add_f32 v66, v66, v74
    v_add_f32 v67, v67, v75
    v_add_f32 v68, v68, v76
    v_add_f32 v69, v69, v77
    v_add_f32 v70, v70, v78
    v_add_f32 v71, v71, v79
    s_waitcnt lgkmcnt(8)
    v_add_f32 v80, v80, v88
    v_add_f32 v81, v81, v89
    v_add_f32 v82, v82, v90
    v_add_f32 v83, v83, v91
    v_add_f32 v84, v84, v92
    v_add_f32 v85, v85, v93
    v_add_f32 v86, v86, v94
    v_add_f32 v87, v87, v95
    v_add_f32 v32, v32, v48
    v_add_f32 v64, v64, v80
    v_add_f32 v33, v33, v49
    v_add_f32 v65, v65, v81
    v_add_f32 v34, v34, v50
    v_add_f32 v66, v66, v82
    v_add_f32 v35, v35, v51
    v_add_f32 v67, v67, v83
    v_add_f32 v36, v36, v52
    v_add_f32 v68, v68, v84
    v_add_f32 v37, v37, v53
    v_add_f32 v69, v69, v85
    v_add_f32 v38, v38, v54
    v_add_f32 v70, v70, v86
    v_add_f32 v39, v39, v55
    v_add_f32 v71, v71, v87
    v_add_f32 v32, v32, v64
    v_add_f32 v33, v33, v65
    v_add_f32 v34, v34, v66
    v_add_f32 v35, v35, v67
    v_add_f32 v36, v36, v68
    v_add_f32 v37, v37, v69
    v_add_f32 v38, v38, v70
    v_add_f32 v39, v39, v71
    s_waitcnt lgkmcnt(0)
    v_cvt_pk_bf16_f32 v106, v32, v33
    v_lshlrev_b32 v32, 16, v106
    v_and_b32 v33, s77, v106
    v_mul_f32 v112, v112, v96
    v_mul_f32 v113, v113, v97
    v_mul_f32 v32, v32, v105
    v_mul_f32 v33, v33, v105
    v_cvt_pk_bf16_f32 v107, v112, v113
    v_lshlrev_b32 v112, 16, v107
    v_and_b32 v113, s77, v107
    v_mul_f32 v112, v112, v104
    v_mul_f32 v113, v113, v104
    v_cvt_pk_bf16_f32 v106, v32, v33
    v_lshlrev_b32 v32, 16, v106
    v_and_b32 v33, s77, v106
    v_cvt_pk_bf16_f32 v107, v112, v113
    v_lshlrev_b32 v112, 16, v107
    v_and_b32 v113, s77, v107
    v_add_f32 v32, v32, v112
    v_add_f32 v33, v33, v113
    v_cvt_pk_bf16_f32 v48, v32, v33
    v_cvt_pk_bf16_f32 v108, v34, v35
    v_lshlrev_b32 v34, 16, v108
    v_and_b32 v35, s77, v108
    v_mul_f32 v114, v114, v98
    v_mul_f32 v115, v115, v99
    v_mul_f32 v34, v34, v105
    v_mul_f32 v35, v35, v105
    v_cvt_pk_bf16_f32 v109, v114, v115
    v_lshlrev_b32 v114, 16, v109
    v_and_b32 v115, s77, v109
    v_mul_f32 v114, v114, v104
    v_mul_f32 v115, v115, v104
    v_cvt_pk_bf16_f32 v108, v34, v35
    v_lshlrev_b32 v34, 16, v108
    v_and_b32 v35, s77, v108
    v_cvt_pk_bf16_f32 v109, v114, v115
    v_lshlrev_b32 v114, 16, v109
    v_and_b32 v115, s77, v109
    v_add_f32 v34, v34, v114
    v_add_f32 v35, v35, v115
    v_cvt_pk_bf16_f32 v49, v34, v35
    v_cvt_pk_bf16_f32 v106, v36, v37
    v_lshlrev_b32 v36, 16, v106
    v_and_b32 v37, s77, v106
    v_mul_f32 v116, v116, v100
    v_mul_f32 v117, v117, v101
    v_mul_f32 v36, v36, v105
    v_mul_f32 v37, v37, v105
    v_cvt_pk_bf16_f32 v107, v116, v117
    v_lshlrev_b32 v116, 16, v107
    v_and_b32 v117, s77, v107
    v_mul_f32 v116, v116, v104
    v_mul_f32 v117, v117, v104
    v_cvt_pk_bf16_f32 v106, v36, v37
    v_lshlrev_b32 v36, 16, v106
    v_and_b32 v37, s77, v106
    v_cvt_pk_bf16_f32 v107, v116, v117
    v_lshlrev_b32 v116, 16, v107
    v_and_b32 v117, s77, v107
    v_add_f32 v36, v36, v116
    v_add_f32 v37, v37, v117
    v_cvt_pk_bf16_f32 v50, v36, v37
    v_cvt_pk_bf16_f32 v108, v38, v39
    v_lshlrev_b32 v38, 16, v108
    v_and_b32 v39, s77, v108
    v_mul_f32 v118, v118, v102
    v_mul_f32 v119, v119, v103
    v_mul_f32 v38, v38, v105
    v_mul_f32 v39, v39, v105
    v_cvt_pk_bf16_f32 v109, v118, v119
    v_lshlrev_b32 v118, 16, v109
    v_and_b32 v119, s77, v109
    v_mul_f32 v118, v118, v104
    v_mul_f32 v119, v119, v104
    v_cvt_pk_bf16_f32 v108, v38, v39
    v_lshlrev_b32 v38, 16, v108
    v_and_b32 v39, s77, v108
    v_cvt_pk_bf16_f32 v109, v118, v119
    v_lshlrev_b32 v118, 16, v109
    v_and_b32 v119, s77, v109
    v_add_f32 v38, v38, v118
    v_add_f32 v39, v39, v119
    v_cvt_pk_bf16_f32 v51, v38, v39
    buffer_store_dwordx4 v[48:51], v26, s[40:43], 0 offen
    s_lshl_b32 s62, s57, 2
    s_add_u32 s62, s62, s56
    s_lshl_b32 s62, s62, 4
    s_add_u32 s62, s62, s58
    s_cmp_lg_u32 s62, 15
    s_cbranch_scc1 L_noep2
    s_mov_b32 s63, 0xb01000
    buffer_load_dwordx4 v[96:99], v2, s[44:47], s63 offen sc1
    s_mov_b32 s63, 0xb01400
    buffer_load_dwordx4 v[100:103], v2, s[44:47], s63 offen sc1
    s_mov_b32 s63, 0xb01800
    buffer_load_dwordx4 v[104:107], v2, s[44:47], s63 offen sc1
    s_mov_b32 s63, 0xb01c00
    buffer_load_dwordx4 v[108:111], v2, s[44:47], s63 offen sc1
    s_waitcnt vmcnt(0)
    s_mov_b32 s72, 0xb01000
    s_mov_b32 s86, 0
L_pc27:
    v_xor_b32 v96, s61, v96
    v_xor_b32 v97, s61, v97
    v_xor_b32 v98, s61, v98
    v_xor_b32 v99, s61, v99
    v_or3_b32 v96, v96, v97, v98
    v_or_b32 v96, v96, v99
    v_cmp_eq_u32 vcc, 0, v96
    s_nop 1
    s_cmp_eq_u64 vcc, -1
    s_cbranch_scc1 L_pd27
    s_add_u32 s86, s86, 1
    s_cmp_ge_u32 s86, 200000
    s_cbranch_scc1 L_pd27
    s_sleep 20
    buffer_load_dwordx4 v[96:99], v2, s[44:47], s72 offen sc1
    s_waitcnt vmcnt(0)
    s_branch L_pc27
L_pd27:
    s_mov_b32 s72, 0xb01400
    s_mov_b32 s86, 0
L_pc28:
    v_xor_b32 v100, s61, v100
    v_xor_b32 v101, s61, v101
    v_xor_b32 v102, s61, v102
    v_xor_b32 v103, s61, v103
    v_or3_b32 v100, v100, v101, v102
    v_or_b32 v100, v100, v103
    v_cmp_eq_u32 vcc, 0, v100
    s_nop 1
    s_cmp_eq_u64 vcc, -1
    s_cbranch_scc1 L_pd28
    s_add_u32 s86, s86, 1
    s_cmp_ge_u32 s86, 200000
    s_cbranch_scc1 L_pd28
    s_sleep 20
    buffer_load_dwordx4 v[100:103], v2, s[44:47], s72 offen sc1
    s_waitcnt vmcnt(0)
    s_branch L_pc28
L_pd28:
    s_mov_b32 s72, 0xb01800
    s_mov_b32 s86, 0
L_pc29:
    v_xor_b32 v104, s61, v104
    v_xor_b32 v105, s61, v105
    v_xor_b32 v106, s61, v106
    v_xor_b32 v107, s61, v107
    v_or3_b32 v104, v104, v105, v106
    v_or_b32 v104, v104, v107
    v_cmp_eq_u32 vcc, 0, v104
    s_nop 1
    s_cmp_eq_u64 vcc, -1
    s_cbranch_scc1 L_pd29
    s_add_u32 s86, s86, 1
    s_cmp_ge_u32 s86, 200000
    s_cbranch_scc1 L_pd29
    s_sleep 20
    buffer_load_dwordx4 v[104:107], v2, s[44:47], s72 offen sc1
    s_waitcnt vmcnt(0)
    s_branch L_pc29
L_pd29:
    s_mov_b32 s72, 0xb01c00
    s_mov_b32 s86, 0
L_pc30:
    v_xor_b32 v108, s61, v108
    v_xor_b32 v109, s61, v109
    v_xor_b32 v110, s61, v110
    v_xor_b32 v111, s61, v111
    v_or3_b32 v108, v108, v109, v110
    v_or_b32 v108, v108, v111
    v_cmp_eq_u32 vcc, 0, v108
    s_nop 1
    s_cmp_eq_u64 vcc, -1
    s_cbranch_scc1 L_pd30
    s_add_u32 s86, s86, 1
    s_cmp_ge_u32 s86, 200000
    s_cbranch_scc1 L_pd30
    s_sleep 20
    buffer_load_dwordx4 v[108:111], v2, s[44:47], s72 offen sc1
    s_waitcnt vmcnt(0)
    s_branch L_pc30
L_pd30:
    s_sub_u32 s62, s61, 0x9e3779b8
    v_mov_b32 v13, s62
    v_mov_b32 v14, 0
    s_mov_b32 s63, 0xb00000
    s_mov_b64 exec, 1
    buffer_store_dword v13, v14, s[44:47], s63 offen sc1
    s_mov_b64 exec, -1
L_noep2:
    s_branch L_fin
L_compute:
    v_lshrrev_b32 v13, 5, v1
    v_lshlrev_b32 v13, 3, v13
    v_bfe_u32 v14, v1, 2, 2
    v_add_u32 v13, v13, v14
    v_mul_u32_u24 v13, 192, v13
    v_bfe_u32 v14, v1, 4, 1
    v_lshl_add_u32 v13, v14, 5, v13
    v_and_b32 v14, 3, v1
    v_lshl_add_u32 v13, v14, 3, v13
    v_add_u32 v3, 41216, v13
    v_add_u32 v4, 82432, v13
    v_add_u32 v5, 0, v13
    v_bfe_u32 v13, v1, 3, 2
    v_mul_u32_u24 v13, 1040, v13
    v_and_b32 v14, 7, v1
    v_lshl_add_u32 v13, v14, 7, v13
    v_lshrrev_b32 v14, 5, v1
    v_lshl_add_u32 v13, v14, 4, v13
    s_mul_i32 s62, s56, 4160
    v_add_u32 v13, s62, v13
    v_add_u32 v6, 65792, v13
    v_add_u32 v7, 107008, v13
    v_add_u32 v8, 24576, v13
    v_mov_b32 v9, 0xc0135761
    s_mov_b32 s76, 0xbdd2d3e8
    s_lshl_b32 s62, s57, 2
    s_add_u32 s62, s62, s56
    s_mul_i32 s63, s62, 43
    s_mul_i32 s64, s58, 3
    s_add_u32 s63, s63, s64
    s_lshl_b32 s83, s63, 11
    s_lshr_b32 s63, s62, 1
    s_lshl_b32 s63, s63, 9
    s_and_b32 s62, s62, 1
    s_lshl_b32 s64, s58, 1
    s_add_u32 s62, s62, s64
    s_lshl_b32 s62, s62, 2
    s_add_u32 s62, s62, s63
    s_add_u32 s84, s62, 0xb02000
    v_lshrrev_b32 v13, 3, v1
    v_bfe_u32 v14, v1, 4, 1
    v_lshlrev_b32 v14, 2, v14
    v_and_b32 v15, 7, v1
    v_xor_b32 v15, v15, v14
    v_lshlrev_b32 v15, 4, v15
    v_lshl_add_u32 v15, v13, 10, v15
    s_lshl_b32 s62, s60, 7
    v_add_u32 v28, s62, v15
    v_add_u32 v29, 7168, v28
    v_add_u32 v30, 14336, v28
    v_add_u32 v31, 21504, v28
    s_lshl_b32 s89, s56, 12
    s_mov_b32 s63, s89
    v_lshrrev_b32 v13, 5, v1
    v_lshlrev_b32 v13, 9, v13
    v_bfe_u32 v14, v1, 2, 2
    v_lshl_add_u32 v13, v14, 7, v13
    v_bfe_u32 v14, v1, 4, 1
    v_lshl_add_u32 v13, v14, 5, v13
    v_and_b32 v14, 3, v1
    v_lshl_add_u32 v13, v14, 3, v13
    v_bfe_u32 v14, v1, 3, 1
    v_lshl_add_u32 v13, v14, 6, v13
    v_add_u32 v10, s63, v13
    v_xor_b32 v14, 64, v13
    v_add_u32 v11, s63, v14
    s_mul_i32 s62, s56, 6144
    s_add_u32 s90, s62, 0
    s_add_u32 s91, s62, 24576
    s_add_u32 s92, s62, 49152
    s_add_u32 s93, s62, 73728
    s_cmp_eq_u32 s56, 3
    s_cselect_b32 s93, 2048, s93
    s_add_u32 s94, s62, 8192
    s_add_u32 s95, s62, 32768
    s_add_u32 s96, s62, 57344
    s_add_u32 s97, s62, 0xfffff800
    s_cmp_eq_u32 s56, 0
    s_cselect_b32 s97, 81920, s97
    s_add_u32 s98, s62, 22528
    s_add_u32 s99, s62, 47104
    s_add_u32 s100, s62, 71680
    s_mul_i32 s82, s59, 176128
    v_lshrrev_b32 v13, 3, v0
    v_and_b32 v14, 7, v0
    v_lshlrev_b32 v14, 4, v14
    v_lshl_add_u32 v13, v13, 10, v14
    s_lshl_b32 s62, s59, 16
    s_lshl_b32 s63, s60, 7
    s_add_u32 s62, s62, s63
    v_add_u32 v26, s62, v13
    v_lshrrev_b32 v14, 3, v0
    v_sub_u32 v14, 31, v14
    v_lshrrev_b32 v156, 2, v14
    v_and_b32 v16, 7, v0
    v_xor_b32 v156, v156, v16
    v_lshlrev_b32 v156, 4, v156
    v_and_b32 v14, 3, v14
    v_lshl_add_u32 v156, v14, 2, v156
    v_lshl_add_u32 v156, v16, 10, v156
    v_add_u32 v156, 148480, v156
    v_lshlrev_b32 v157, 6, v16
    v_add_u32 v157, 161280, v157
    s_cmp_eq_u32 s58, 15
    s_cbranch_scc1 L_c_g
    s_waitcnt vmcnt(1)
    ds_read_b128 v[136:139], v157 offset:0
    v_accvgpr_read_b32 v128, a56
    v_accvgpr_read_b32 v129, a60
    v_accvgpr_read_b32 v130, a64
    v_accvgpr_read_b32 v131, a68
    v_accvgpr_read_b32 v132, a72
    v_accvgpr_read_b32 v133, a76
    v_accvgpr_read_b32 v134, a80
    s_waitcnt lgkmcnt(0)
    v_lshlrev_b32 v140, 16, v128
    v_lshlrev_b32 v141, 16, v129
    v_lshlrev_b32 v142, 16, v130
    v_lshlrev_b32 v143, 16, v131
    v_lshlrev_b32 v144, 16, v132
    v_lshlrev_b32 v145, 16, v133
    v_lshlrev_b32 v146, 16, v134
    v_lshlrev_b32 v147, 16, v136
    v_and_b32 v148, s77, v136
    v_lshlrev_b32 v149, 16, v137
    v_and_b32 v150, s77, v137
    v_mul_f32 v153, v140, v150
    v_mul_f32 v154, v141, v150
    v_cvt_pk_bf16_f32 v155, v153, v154
    v_lshlrev_b32 v153, 16, v155
    v_and_b32 v154, s77, v155
    v_mul_f32 v151, v141, v149
    v_mul_f32 v152, v142, v149
    v_cvt_pk_bf16_f32 v155, v151, v152
    v_lshlrev_b32 v151, 16, v155
    v_and_b32 v152, s77, v155
    v_add_f32 v153, v153, v151
    v_add_f32 v154, v154, v152
    v_cvt_pk_bf16_f32 v155, v153, v154
    v_lshlrev_b32 v153, 16, v155
    v_and_b32 v154, s77, v155
    v_mul_f32 v151, v142, v148
    v_mul_f32 v152, v143, v148
    v_cvt_pk_bf16_f32 v155, v151, v152
    v_lshlrev_b32 v151, 16, v155
    v_and_b32 v152, s77, v155
    v_add_f32 v153, v153, v151
    v_add_f32 v154, v154, v152
    v_cvt_pk_bf16_f32 v155, v153, v154
    v_lshlrev_b32 v153, 16, v155
    v_and_b32 v154, s77, v155
    v_mul_f32 v151, v143, v147
    v_mul_f32 v152, v144, v147
    v_cvt_pk_bf16_f32 v155, v151, v152
    v_lshlrev_b32 v151, 16, v155
    v_and_b32 v152, s77, v155
    v_add_f32 v153, v153, v151
    v_add_f32 v154, v154, v152
    v_cvt_pk_bf16_f32 v155, v153, v154
    v_lshlrev_b32 v153, 16, v155
    v_and_b32 v154, s77, v155
    v_mul_f32 v153, v153, v145
    v_mul_f32 v154, v154, v146
    v_cvt_pk_bf16_f32 v151, v154, v153
    ds_write_b32 v156, v151 offset:0
    v_and_b32 v140, s77, v128
    v_and_b32 v141, s77, v129
    v_and_b32 v142, s77, v130
    v_and_b32 v143, s77, v131
    v_and_b32 v144, s77, v132
    v_and_b32 v145, s77, v133
    v_and_b32 v146, s77, v134
    v_lshlrev_b32 v147, 16, v138
    v_and_b32 v148, s77, v138
    v_lshlrev_b32 v149, 16, v139
    v_and_b32 v150, s77, v139
    v_mul_f32 v153, v140, v150
    v_mul_f32 v154, v141, v150
    v_cvt_pk_bf16_f32 v155, v153, v154
    v_lshlrev_b32 v153, 16, v155
    v_and_b32 v154, s77, v155
    v_mul_f32 v151, v141, v149
    v_mul_f32 v152, v142, v149
    v_cvt_pk_bf16_f32 v155, v151, v152
    v_lshlrev_b32 v151, 16, v155
    v_and_b32 v152, s77, v155
    v_add_f32 v153, v153, v151
    v_add_f32 v154, v154, v152
    v_cvt_pk_bf16_f32 v155, v153, v154
    v_lshlrev_b32 v153, 16, v155
    v_and_b32 v154, s77, v155
    v_mul_f32 v151, v142, v148
    v_mul_f32 v152, v143, v148
    v_cvt_pk_bf16_f32 v155, v151, v152
    v_lshlrev_b32 v151, 16, v155
    v_and_b32 v152, s77, v155
    v_add_f32 v153, v153, v151
    v_add_f32 v154, v154, v152
    v_cvt_pk_bf16_f32 v155, v153, v154
    v_lshlrev_b32 v153, 16, v155
    v_and_b32 v154, s77, v155
    v_mul_f32 v151, v143, v147
    v_mul_f32 v152, v144, v147
    v_cvt_pk_bf16_f32 v155, v151, v152
    v_lshlrev_b32 v151, 16, v155
    v_and_b32 v152, s77, v155
    v_add_f32 v153, v153, v151
    v_add_f32 v154, v154, v152
    v_cvt_pk_bf16_f32 v155, v153, v154
    v_lshlrev_b32 v153, 16, v155
    v_and_b32 v154, s77, v155
    v_mul_f32 v153, v153, v145
    v_mul_f32 v154, v154, v146
    v_cvt_pk_bf16_f32 v151, v154, v153
    ds_write_b32 v156, v151 offset:128
    ds_read_b128 v[136:139], v157 offset:16
    v_accvgpr_read_b32 v128, a57
    v_accvgpr_read_b32 v129, a61
    v_accvgpr_read_b32 v130, a65
    v_accvgpr_read_b32 v131, a69
    v_accvgpr_read_b32 v132, a73
    v_accvgpr_read_b32 v133, a77
    v_accvgpr_read_b32 v134, a81
    s_waitcnt lgkmcnt(0)
    v_lshlrev_b32 v140, 16, v128
    v_lshlrev_b32 v141, 16, v129
    v_lshlrev_b32 v142, 16, v130
    v_lshlrev_b32 v143, 16, v131
    v_lshlrev_b32 v144, 16, v132
    v_lshlrev_b32 v145, 16, v133
    v_lshlrev_b32 v146, 16, v134
    v_lshlrev_b32 v147, 16, v136
    v_and_b32 v148, s77, v136
    v_lshlrev_b32 v149, 16, v137
    v_and_b32 v150, s77, v137
    v_mul_f32 v153, v140, v150
    v_mul_f32 v154, v141, v150
    v_cvt_pk_bf16_f32 v155, v153, v154
    v_lshlrev_b32 v153, 16, v155
    v_and_b32 v154, s77, v155
    v_mul_f32 v151, v141, v149
    v_mul_f32 v152, v142, v149
    v_cvt_pk_bf16_f32 v155, v151, v152
    v_lshlrev_b32 v151, 16, v155
    v_and_b32 v152, s77, v155
    v_add_f32 v153, v153, v151
    v_add_f32 v154, v154, v152
    v_cvt_pk_bf16_f32 v155, v153, v154
    v_lshlrev_b32 v153, 16, v155
    v_and_b32 v154, s77, v155
    v_mul_f32 v151, v142, v148
    v_mul_f32 v152, v143, v148
    v_cvt_pk_bf16_f32 v155, v151, v152
    v_lshlrev_b32 v151, 16, v155
    v_and_b32 v152, s77, v155
    v_add_f32 v153, v153, v151
    v_add_f32 v154, v154, v152
    v_cvt_pk_bf16_f32 v155, v153, v154
    v_lshlrev_b32 v153, 16, v155
    v_and_b32 v154, s77, v155
    v_mul_f32 v151, v143, v147
    v_mul_f32 v152, v144, v147
    v_cvt_pk_bf16_f32 v155, v151, v152
    v_lshlrev_b32 v151, 16, v155
    v_and_b32 v152, s77, v155
    v_add_f32 v153, v153, v151
    v_add_f32 v154, v154, v152
    v_cvt_pk_bf16_f32 v155, v153, v154
    v_lshlrev_b32 v153, 16, v155
    v_and_b32 v154, s77, v155
    v_mul_f32 v153, v153, v145
    v_mul_f32 v154, v154, v146
    v_cvt_pk_bf16_f32 v151, v154, v153
    ds_write_b32 v156, v151 offset:256
    v_and_b32 v140, s77, v128
    v_and_b32 v141, s77, v129
    v_and_b32 v142, s77, v130
    v_and_b32 v143, s77, v131
    v_and_b32 v144, s77, v132
    v_and_b32 v145, s77, v133
    v_and_b32 v146, s77, v134
    v_lshlrev_b32 v147, 16, v138
    v_and_b32 v148, s77, v138
    v_lshlrev_b32 v149, 16, v139
    v_and_b32 v150, s77, v139
    v_mul_f32 v153, v140, v150
    v_mul_f32 v154, v141, v150
    v_cvt_pk_bf16_f32 v155, v153, v154
    v_lshlrev_b32 v153, 16, v155
    v_and_b32 v154, s77, v155
    v_mul_f32 v151, v141, v149
    v_mul_f32 v152, v142, v149
    v_cvt_pk_bf16_f32 v155, v151, v152
    v_lshlrev_b32 v151, 16, v155
    v_and_b32 v152, s77, v155
    v_add_f32 v153, v153, v151
    v_add_f32 v154, v154, v152
    v_cvt_pk_bf16_f32 v155, v153, v154
    v_lshlrev_b32 v153, 16, v155
    v_and_b32 v154, s77, v155
    v_mul_f32 v151, v142, v148
    v_mul_f32 v152, v143, v148
    v_cvt_pk_bf16_f32 v155, v151, v152
    v_lshlrev_b32 v151, 16, v155
    v_and_b32 v152, s77, v155
    v_add_f32 v153, v153, v151
    v_add_f32 v154, v154, v152
    v_cvt_pk_bf16_f32 v155, v153, v154
    v_lshlrev_b32 v153, 16, v155
    v_and_b32 v154, s77, v155
    v_mul_f32 v151, v143, v147
    v_mul_f32 v152, v144, v147
    v_cvt_pk_bf16_f32 v155, v151, v152
    v_lshlrev_b32 v151, 16, v155
    v_and_b32 v152, s77, v155
    v_add_f32 v153, v153, v151
    v_add_f32 v154, v154, v152
    v_cvt_pk_bf16_f32 v155, v153, v154
    v_lshlrev_b32 v153, 16, v155
    v_and_b32 v154, s77, v155
    v_mul_f32 v153, v153, v145
    v_mul_f32 v154, v154, v146
    v_cvt_pk_bf16_f32 v151, v154, v153
    ds_write_b32 v156, v151 offset:384
    ds_read_b128 v[136:139], v157 offset:32
    v_accvgpr_read_b32 v128, a58
    v_accvgpr_read_b32 v129, a62
    v_accvgpr_read_b32 v130, a66
    v_accvgpr_read_b32 v131, a70
    v_accvgpr_read_b32 v132, a74
    v_accvgpr_read_b32 v133, a78
    v_accvgpr_read_b32 v134, a82
    s_waitcnt lgkmcnt(0)
    v_lshlrev_b32 v140, 16, v128
    v_lshlrev_b32 v141, 16, v129
    v_lshlrev_b32 v142, 16, v130
    v_lshlrev_b32 v143, 16, v131
    v_lshlrev_b32 v144, 16, v132
    v_lshlrev_b32 v145, 16, v133
    v_lshlrev_b32 v146, 16, v134
    v_lshlrev_b32 v147, 16, v136
    v_and_b32 v148, s77, v136
    v_lshlrev_b32 v149, 16, v137
    v_and_b32 v150, s77, v137
    v_mul_f32 v153, v140, v150
    v_mul_f32 v154, v141, v150
    v_cvt_pk_bf16_f32 v155, v153, v154
    v_lshlrev_b32 v153, 16, v155
    v_and_b32 v154, s77, v155
    v_mul_f32 v151, v141, v149
    v_mul_f32 v152, v142, v149
    v_cvt_pk_bf16_f32 v155, v151, v152
    v_lshlrev_b32 v151, 16, v155
    v_and_b32 v152, s77, v155
    v_add_f32 v153, v153, v151
    v_add_f32 v154, v154, v152
    v_cvt_pk_bf16_f32 v155, v153, v154
    v_lshlrev_b32 v153, 16, v155
    v_and_b32 v154, s77, v155
    v_mul_f32 v151, v142, v148
    v_mul_f32 v152, v143, v148
    v_cvt_pk_bf16_f32 v155, v151, v152
    v_lshlrev_b32 v151, 16, v155
    v_and_b32 v152, s77, v155
    v_add_f32 v153, v153, v151
    v_add_f32 v154, v154, v152
    v_cvt_pk_bf16_f32 v155, v153, v154
    v_lshlrev_b32 v153, 16, v155
    v_and_b32 v154, s77, v155
    v_mul_f32 v151, v143, v147
    v_mul_f32 v152, v144, v147
    v_cvt_pk_bf16_f32 v155, v151, v152
    v_lshlrev_b32 v151, 16, v155
    v_and_b32 v152, s77, v155
    v_add_f32 v153, v153, v151
    v_add_f32 v154, v154, v152
    v_cvt_pk_bf16_f32 v155, v153, v154
    v_lshlrev_b32 v153, 16, v155
    v_and_b32 v154, s77, v155
    v_mul_f32 v153, v153, v145
    v_mul_f32 v154, v154, v146
    v_cvt_pk_bf16_f32 v151, v154, v153
    ds_write_b32 v156, v151 offset:512
    v_and_b32 v140, s77, v128
    v_and_b32 v141, s77, v129
    v_and_b32 v142, s77, v130
    v_and_b32 v143, s77, v131
    v_and_b32 v144, s77, v132
    v_and_b32 v145, s77, v133
    v_and_b32 v146, s77, v134
    v_lshlrev_b32 v147, 16, v138
    v_and_b32 v148, s77, v138
    v_lshlrev_b32 v149, 16, v139
    v_and_b32 v150, s77, v139
    v_mul_f32 v153, v140, v150
    v_mul_f32 v154, v141, v150
    v_cvt_pk_bf16_f32 v155, v153, v154
    v_lshlrev_b32 v153, 16, v155
    v_and_b32 v154, s77, v155
    v_mul_f32 v151, v141, v149
    v_mul_f32 v152, v142, v149
    v_cvt_pk_bf16_f32 v155, v151, v152
    v_lshlrev_b32 v151, 16, v155
    v_and_b32 v152, s77, v155
    v_add_f32 v153, v153, v151
    v_add_f32 v154, v154, v152
    v_cvt_pk_bf16_f32 v155, v153, v154
    v_lshlrev_b32 v153, 16, v155
    v_and_b32 v154, s77, v155
    v_mul_f32 v151, v142, v148
    v_mul_f32 v152, v143, v148
    v_cvt_pk_bf16_f32 v155, v151, v152
    v_lshlrev_b32 v151, 16, v155
    v_and_b32 v152, s77, v155
    v_add_f32 v153, v153, v151
    v_add_f32 v154, v154, v152
    v_cvt_pk_bf16_f32 v155, v153, v154
    v_lshlrev_b32 v153, 16, v155
    v_and_b32 v154, s77, v155
    v_mul_f32 v151, v143, v147
    v_mul_f32 v152, v144, v147
    v_cvt_pk_bf16_f32 v155, v151, v152
    v_lshlrev_b32 v151, 16, v155
    v_and_b32 v152, s77, v155
    v_add_f32 v153, v153, v151
    v_add_f32 v154, v154, v152
    v_cvt_pk_bf16_f32 v155, v153, v154
    v_lshlrev_b32 v153, 16, v155
    v_and_b32 v154, s77, v155
    v_mul_f32 v153, v153, v145
    v_mul_f32 v154, v154, v146
    v_cvt_pk_bf16_f32 v151, v154, v153
    ds_write_b32 v156, v151 offset:640
    ds_read_b128 v[136:139], v157 offset:48
    v_accvgpr_read_b32 v128, a59
    v_accvgpr_read_b32 v129, a63
    v_accvgpr_read_b32 v130, a67
    v_accvgpr_read_b32 v131, a71
    v_accvgpr_read_b32 v132, a75
    v_accvgpr_read_b32 v133, a79
    v_accvgpr_read_b32 v134, a83
    s_waitcnt lgkmcnt(0)
    v_lshlrev_b32 v140, 16, v128
    v_lshlrev_b32 v141, 16, v129
    v_lshlrev_b32 v142, 16, v130
    v_lshlrev_b32 v143, 16, v131
    v_lshlrev_b32 v144, 16, v132
    v_lshlrev_b32 v145, 16, v133
    v_lshlrev_b32 v146, 16, v134
    v_lshlrev_b32 v147, 16, v136
    v_and_b32 v148, s77, v136
    v_lshlrev_b32 v149, 16, v137
    v_and_b32 v150, s77, v137
    v_mul_f32 v153, v140, v150
    v_mul_f32 v154, v141, v150
    v_cvt_pk_bf16_f32 v155, v153, v154
    v_lshlrev_b32 v153, 16, v155
    v_and_b32 v154, s77, v155
    v_mul_f32 v151, v141, v149
    v_mul_f32 v152, v142, v149
    v_cvt_pk_bf16_f32 v155, v151, v152
    v_lshlrev_b32 v151, 16, v155
    v_and_b32 v152, s77, v155
    v_add_f32 v153, v153, v151
    v_add_f32 v154, v154, v152
    v_cvt_pk_bf16_f32 v155, v153, v154
    v_lshlrev_b32 v153, 16, v155
    v_and_b32 v154, s77, v155
    v_mul_f32 v151, v142, v148
    v_mul_f32 v152, v143, v148
    v_cvt_pk_bf16_f32 v155, v151, v152
    v_lshlrev_b32 v151, 16, v155
    v_and_b32 v152, s77, v155
    v_add_f32 v153, v153, v151
    v_add_f32 v154, v154, v152
    v_cvt_pk_bf16_f32 v155, v153, v154
    v_lshlrev_b32 v153, 16, v155
    v_and_b32 v154, s77, v155
    v_mul_f32 v151, v143, v147
    v_mul_f32 v152, v144, v147
    v_cvt_pk_bf16_f32 v155, v151, v152
    v_lshlrev_b32 v151, 16, v155
    v_and_b32 v152, s77, v155
    v_add_f32 v153, v153, v151
    v_add_f32 v154, v154, v152
    v_cvt_pk_bf16_f32 v155, v153, v154
    v_lshlrev_b32 v153, 16, v155
    v_and_b32 v154, s77, v155
    v_mul_f32 v153, v153, v145
    v_mul_f32 v154, v154, v146
    v_cvt_pk_bf16_f32 v151, v154, v153
    ds_write_b32 v156, v151 offset:768
    v_and_b32 v140, s77, v128
    v_and_b32 v141, s77, v129
    v_and_b32 v142, s77, v130
    v_and_b32 v143, s77, v131
    v_and_b32 v144, s77, v132
    v_and_b32 v145, s77, v133
    v_and_b32 v146, s77, v134
    v_lshlrev_b32 v147, 16, v138
    v_and_b32 v148, s77, v138
    v_lshlrev_b32 v149, 16, v139
    v_and_b32 v150, s77, v139
    v_mul_f32 v153, v140, v150
    v_mul_f32 v154, v141, v150
    v_cvt_pk_bf16_f32 v155, v153, v154
    v_lshlrev_b32 v153, 16, v155
    v_and_b32 v154, s77, v155
    v_mul_f32 v151, v141, v149
    v_mul_f32 v152, v142, v149
    v_cvt_pk_bf16_f32 v155, v151, v152
    v_lshlrev_b32 v151, 16, v155
    v_and_b32 v152, s77, v155
    v_add_f32 v153, v153, v151
    v_add_f32 v154, v154, v152
    v_cvt_pk_bf16_f32 v155, v153, v154
    v_lshlrev_b32 v153, 16, v155
    v_and_b32 v154, s77, v155
    v_mul_f32 v151, v142, v148
    v_mul_f32 v152, v143, v148
    v_cvt_pk_bf16_f32 v155, v151, v152
    v_lshlrev_b32 v151, 16, v155
    v_and_b32 v152, s77, v155
    v_add_f32 v153, v153, v151
    v_add_f32 v154, v154, v152
    v_cvt_pk_bf16_f32 v155, v153, v154
    v_lshlrev_b32 v153, 16, v155
    v_and_b32 v154, s77, v155
    v_mul_f32 v151, v143, v147
    v_mul_f32 v152, v144, v147
    v_cvt_pk_bf16_f32 v155, v151, v152
    v_lshlrev_b32 v151, 16, v155
    v_and_b32 v152, s77, v155
    v_add_f32 v153, v153, v151
    v_add_f32 v154, v154, v152
    v_cvt_pk_bf16_f32 v155, v153, v154
    v_lshlrev_b32 v153, 16, v155
    v_and_b32 v154, s77, v155
    v_mul_f32 v153, v153, v145
    v_mul_f32 v154, v154, v146
    v_cvt_pk_bf16_f32 v151, v154, v153
    ds_write_b32 v156, v151 offset:896
    s_waitcnt vmcnt(0)
    v_readfirstlane_b32 s61, v24
    s_nop 3
    s_add_u32 s61, s61, 0x9e3779b9
    v_lshrrev_b32 v14, 3, v0
    v_lshrrev_b32 v13, 6, v0
    v_and_b32 v154, 7, v0
    v_xor_b32 v13, v13, v154
    v_lshlrev_b32 v13, 4, v13
    v_lshl_add_u32 v13, v14, 7, v13
    v_xor_b32 v153, 64, v13
    v_add_u32 v152, 148480, v13
    v_add_u32 v153, 148480, v153
    v_lshlrev_b32 v154, 4, v154
    v_lshl_add_u32 v154, v14, 12, v154
    s_waitcnt lgkmcnt(0)
    s_barrier
    ds_read_b128 a[48:51], v6 offset:0
    ds_read_b64_tr_b16 a[0:1], v3 offset:0
    ds_read_b64_tr_b16 a[2:3], v3 offset:768
    ds_read_b64_tr_b16 a[4:5], v3 offset:12288
    ds_read_b64_tr_b16 a[6:7], v3 offset:13056
    ds_read_b64_tr_b16 a[8:9], v3 offset:64
    ds_read_b64_tr_b16 a[10:11], v3 offset:832
    ds_read_b64_tr_b16 a[12:13], v3 offset:12352
    ds_read_b64_tr_b16 a[14:15], v3 offset:13120
    ds_read_b64_tr_b16 a[16:17], v3 offset:128
    ds_read_b64_tr_b16 a[18:19], v3 offset:896
    ds_read_b64_tr_b16 a[20:21], v3 offset:12416
    ds_read_b64_tr_b16 a[22:23], v3 offset:13184
    s_waitcnt lgkmcnt(8)
    v_mfma_f32_32x32x16_bf16 v[96:111], a[0:3], a[48:51], 0
    ds_read_b128 v[144:147], v152
    ds_read_b128 v[148:151], v153 offset:4096
    ds_read_b128 a[52:55], v6 offset:32
    ds_read_b64_tr_b16 a[24:25], v3 offset:3072
    ds_read_b64_tr_b16 a[26:27], v3 offset:3840
    v_mfma_f32_32x32x16_bf16 v[112:127], a[4:7], a[48:51], 0
    ds_read_b64_tr_b16 a[28:29], v3 offset:15360
    ds_read_b64_tr_b16 a[30:31], v3 offset:16128
    s_waitcnt lgkmcnt(11)
    v_mfma_f32_32x32x16_bf16 v[64:79], a[8:11], a[48:51], 0
    ds_read_b64_tr_b16 a[32:33], v3 offset:3136
    ds_read_b64_tr_b16 a[34:35], v3 offset:3904
    v_mfma_f32_32x32x16_bf16 v[80:95], a[12:15], a[48:51], 0
    ds_read_b64_tr_b16 a[36:37], v3 offset:15424
    ds_read_b64_tr_b16 a[38:39], v3 offset:16192
    s_waitcnt lgkmcnt(11)
    v_mfma_f32_32x32x16_bf16 v[32:47], a[16:19], a[48:51], 0
    s_lshl_b32 s62, s60, 18
    s_lshl_b32 s63, s59, 7
    s_sub_u32 s62, s62, s63
    s_add_u32 s62, s62, 0x600f80
    s_add_u32 s63, s62, 0x20000
    s_waitcnt lgkmcnt(9)
    buffer_store_dwordx4 v[144:147], v154, s[44:47], s62 offen sc1
    buffer_store_dwordx4 v[148:151], v154, s[44:47], s63 offen sc1
    ds_read_b64_tr_b16 a[40:41], v3 offset:3200
    ds_read_b64_tr_b16 a[42:43], v3 offset:3968
    v_mfma_f32_32x32x16_bf16 v[48:63], a[20:23], a[48:51], 0
    ds_read_b64_tr_b16 a[44:45], v3 offset:15488
    ds_read_b64_tr_b16 a[46:47], v3 offset:16256
    s_waitcnt lgkmcnt(8)
    v_mfma_f32_32x32x16_bf16 v[96:111], a[24:27], a[52:55], v[96:111]
    ds_read_b128 a[48:51], v6 offset:64
    ds_read_b64_tr_b16 a[0:1], v3 offset:6144
    ds_read_b64_tr_b16 a[2:3], v3 offset:6912
    v_mfma_f32_32x32x16_bf16 v[112:127], a[28:31], a[52:55], v[112:127]
    ds_read_b64_tr_b16 a[4:5], v3 offset:18432
    ds_read_b64_tr_b16 a[6:7], v3 offset:19200
    s_waitcnt lgkmcnt(9)
    v_mfma_f32_32x32x16_bf16 v[64:79], a[32:35], a[52:55], v[64:79]
    ds_read_b64_tr_b16 a[8:9], v3 offset:6208
    ds_read_b64_tr_b16 a[10:11], v3 offset:6976
    v_mfma_f32_32x32x16_bf16 v[80:95], a[36:39], a[52:55], v[80:95]
    ds_read_b64_tr_b16 a[12:13], v3 offset:18496
    ds_read_b64_tr_b16 a[14:15], v3 offset:19264
    s_waitcnt lgkmcnt(9)
    v_mfma_f32_32x32x16_bf16 v[32:47], a[40:43], a[52:55], v[32:47]
    ds_read_b64_tr_b16 a[16:17], v3 offset:6272
    ds_read_b64_tr_b16 a[18:19], v3 offset:7040
    v_mfma_f32_32x32x16_bf16 v[48:63], a[44:47], a[52:55], v[48:63]
    ds_read_b64_tr_b16 a[20:21], v3 offset:18560
    ds_read_b64_tr_b16 a[22:23], v3 offset:19328
    s_waitcnt lgkmcnt(8)
    v_mfma_f32_32x32x16_bf16 v[96:111], a[0:3], a[48:51], v[96:111]
    ds_read_b128 a[52:55], v6 offset:96
    ds_read_b64_tr_b16 a[24:25], v3 offset:9216
    ds_read_b64_tr_b16 a[26:27], v3 offset:9984
    v_mfma_f32_32x32x16_bf16 v[112:127], a[4:7], a[48:51], v[112:127]
    ds_read_b64_tr_b16 a[28:29], v3 offset:21504
    ds_read_b64_tr_b16 a[30:31], v3 offset:22272
    s_waitcnt lgkmcnt(9)
    v_mfma_f32_32x32x16_bf16 v[64:79], a[8:11], a[48:51], v[64:79]
    ds_read_b64_tr_b16 a[32:33], v3 offset:9280
    ds_read_b64_tr_b16 a[34:35], v3 offset:10048
    v_mfma_f32_32x32x16_bf16 v[80:95], a[12:15], a[48:51], v[80:95]
    ds_read_b64_tr_b16 a[36:37], v3 offset:21568
    ds_read_b64_tr_b16 a[38:39], v3 offset:22336
    s_waitcnt lgkmcnt(9)
    v_mfma_f32_32x32x16_bf16 v[32:47], a[16:19], a[48:51], v[32:47]
    ds_read_b64_tr_b16 a[40:41], v3 offset:9344
    ds_read_b64_tr_b16 a[42:43], v3 offset:10112
    v_mfma_f32_32x32x16_bf16 v[48:63], a[20:23], a[48:51], v[48:63]
    ds_read_b64_tr_b16 a[44:45], v3 offset:21632
    ds_read_b64_tr_b16 a[46:47], v3 offset:22400
    s_waitcnt lgkmcnt(0)
    s_barrier
    v_mfma_f32_32x32x16_bf16 v[96:111], a[24:27], a[52:55], v[96:111]
    ds_read_b128 a[48:51], v7 offset:0
    ds_read_b64_tr_b16 a[0:1], v4 offset:0
    ds_read_b64_tr_b16 a[2:3], v4 offset:768
    v_mfma_f32_32x32x16_bf16 v[112:127], a[28:31], a[52:55], v[112:127]
    ds_read_b64_tr_b16 a[4:5], v4 offset:12288
    ds_read_b64_tr_b16 a[6:7], v4 offset:13056
    v_mfma_f32_32x32x16_bf16 v[64:79], a[32:35], a[52:55], v[64:79]
    ds_read_b64_tr_b16 a[8:9], v4 offset:64
    ds_read_b64_tr_b16 a[10:11], v4 offset:832
    v_mfma_f32_32x32x16_bf16 v[80:95], a[36:39], a[52:55], v[80:95]
    ds_read_b64_tr_b16 a[12:13], v4 offset:12352
    ds_read_b64_tr_b16 a[14:15], v4 offset:13120
    v_mfma_f32_32x32x16_bf16 v[32:47], a[40:43], a[52:55], v[32:47]
    ds_read_b64_tr_b16 a[16:17], v4 offset:128
    ds_read_b64_tr_b16 a[18:19], v4 offset:896
    v_mfma_f32_32x32x16_bf16 v[48:63], a[44:47], a[52:55], v[48:63]
    ds_read_b64_tr_b16 a[20:21], v4 offset:12416
    ds_read_b64_tr_b16 a[22:23], v4 offset:13184
    s_waitcnt lgkmcnt(8)
    v_mfma_f32_32x32x16_bf16 v[96:111], a[0:3], a[48:51], v[96:111]
    ds_read_b128 a[52:55], v7 offset:32
    ds_read_b64_tr_b16 a[24:25], v4 offset:3072
    ds_read_b64_tr_b16 a[26:27], v4 offset:3840
    v_mfma_f32_32x32x16_bf16 v[112:127], a[4:7], a[48:51], v[112:127]
    ds_read_b64_tr_b16 a[28:29], v4 offset:15360
    ds_read_b64_tr_b16 a[30:31], v4 offset:16128
    s_waitcnt lgkmcnt(9)
    v_mfma_f32_32x32x16_bf16 v[64:79], a[8:11], a[48:51], v[64:79]
    ds_read_b64_tr_b16 a[32:33], v4 offset:3136
    ds_read_b64_tr_b16 a[34:35], v4 offset:3904
    v_mfma_f32_32x32x16_bf16 v[80:95], a[12:15], a[48:51], v[80:95]
    ds_read_b64_tr_b16 a[36:37], v4 offset:15424
    ds_read_b64_tr_b16 a[38:39], v4 offset:16192
    s_waitcnt lgkmcnt(9)
    v_mfma_f32_32x32x16_bf16 v[32:47], a[16:19], a[48:51], v[32:47]
    ds_read_b64_tr_b16 a[40:41], v4 offset:3200
    ds_read_b64_tr_b16 a[42:43], v4 offset:3968
    v_mfma_f32_32x32x16_bf16 v[48:63], a[20:23], a[48:51], v[48:63]
    ds_read_b64_tr_b16 a[44:45], v4 offset:15488
    ds_read_b64_tr_b16 a[46:47], v4 offset:16256
    s_waitcnt lgkmcnt(8)
    v_mfma_f32_32x32x16_bf16 v[96:111], a[24:27], a[52:55], v[96:111]
    ds_read_b128 a[48:51], v7 offset:64
    ds_read_b64_tr_b16 a[0:1], v4 offset:6144
    ds_read_b64_tr_b16 a[2:3], v4 offset:6912
    v_mfma_f32_32x32x16_bf16 v[112:127], a[28:31], a[52:55], v[112:127]
    ds_read_b64_tr_b16 a[4:5], v4 offset:18432
    ds_read_b64_tr_b16 a[6:7], v4 offset:19200
    s_waitcnt lgkmcnt(9)
    v_mfma_f32_32x32x16_bf16 v[64:79], a[32:35], a[52:55], v[64:79]
    ds_read_b64_tr_b16 a[8:9], v4 offset:6208
    ds_read_b64_tr_b16 a[10:11], v4 offset:6976
    v_mfma_f32_32x32x16_bf16 v[80:95], a[36:39], a[52:55], v[80:95]
    ds_read_b64_tr_b16 a[12:13], v4 offset:18496
    ds_read_b64_tr_b16 a[14:15], v4 offset:19264
    s_waitcnt lgkmcnt(9)
    v_mfma_f32_32x32x16_bf16 v[32:47], a[40:43], a[52:55], v[32:47]
    ds_read_b64_tr_b16 a[16:17], v4 offset:6272
    ds_read_b64_tr_b16 a[18:19], v4 offset:7040
    v_mfma_f32_32x32x16_bf16 v[48:63], a[44:47], a[52:55], v[48:63]
    ds_read_b64_tr_b16 a[20:21], v4 offset:18560
    ds_read_b64_tr_b16 a[22:23], v4 offset:19328
    s_waitcnt lgkmcnt(8)
    v_mfma_f32_32x32x16_bf16 v[96:111], a[0:3], a[48:51], v[96:111]
    ds_read_b128 a[52:55], v7 offset:96
    ds_read_b64_tr_b16 a[24:25], v4 offset:9216
    ds_read_b64_tr_b16 a[26:27], v4 offset:9984
    v_mfma_f32_32x32x16_bf16 v[112:127], a[4:7], a[48:51], v[112:127]
    ds_read_b64_tr_b16 a[28:29], v4 offset:21504
    ds_read_b64_tr_b16 a[30:31], v4 offset:22272
    s_waitcnt lgkmcnt(9)
    v_mfma_f32_32x32x16_bf16 v[64:79], a[8:11], a[48:51], v[64:79]
    ds_read_b64_tr_b16 a[32:33], v4 offset:9280
    ds_read_b64_tr_b16 a[34:35], v4 offset:10048
    v_mfma_f32_32x32x16_bf16 v[80:95], a[12:15], a[48:51], v[80:95]
    ds_read_b64_tr_b16 a[36:37], v4 offset:21568
    ds_read_b64_tr_b16 a[38:39], v4 offset:22336
    s_waitcnt lgkmcnt(9)
    v_mfma_f32_32x32x16_bf16 v[32:47], a[16:19], a[48:51], v[32:47]
    ds_read_b64_tr_b16 a[40:41], v4 offset:9344
    ds_read_b64_tr_b16 a[42:43], v4 offset:10112
    v_mfma_f32_32x32x16_bf16 v[48:63], a[20:23], a[48:51], v[48:63]
    ds_read_b64_tr_b16 a[44:45], v4 offset:21632
    ds_read_b64_tr_b16 a[46:47], v4 offset:22400
    s_waitcnt lgkmcnt(0)
    s_barrier
    v_mfma_f32_32x32x16_bf16 v[96:111], a[24:27], a[52:55], v[96:111]
    ds_read_b128 a[48:51], v8 offset:0
    ds_read_b64_tr_b16 a[0:1], v5 offset:0
    ds_read_b64_tr_b16 a[2:3], v5 offset:768
    v_mfma_f32_32x32x16_bf16 v[112:127], a[28:31], a[52:55], v[112:127]
    ds_read_b64_tr_b16 a[4:5], v5 offset:12288
    ds_read_b64_tr_b16 a[6:7], v5 offset:13056
    v_mfma_f32_32x32x16_bf16 v[64:79], a[32:35], a[52:55], v[64:79]
    ds_read_b64_tr_b16 a[8:9], v5 offset:64
    ds_read_b64_tr_b16 a[10:11], v5 offset:832
    v_mfma_f32_32x32x16_bf16 v[80:95], a[36:39], a[52:55], v[80:95]
    ds_read_b64_tr_b16 a[12:13], v5 offset:12352
    ds_read_b64_tr_b16 a[14:15], v5 offset:13120
    v_mfma_f32_32x32x16_bf16 v[32:47], a[40:43], a[52:55], v[32:47]
    ds_read_b64_tr_b16 a[16:17], v5 offset:128
    ds_read_b64_tr_b16 a[18:19], v5 offset:896
    v_mfma_f32_32x32x16_bf16 v[48:63], a[44:47], a[52:55], v[48:63]
    ds_read_b64_tr_b16 a[20:21], v5 offset:12416
    ds_read_b64_tr_b16 a[22:23], v5 offset:13184
    s_waitcnt lgkmcnt(8)
    v_mfma_f32_32x32x16_bf16 v[96:111], a[0:3], a[48:51], v[96:111]
    ds_read_b128 a[52:55], v8 offset:32
    ds_read_b64_tr_b16 a[24:25], v5 offset:3072
    ds_read_b64_tr_b16 a[26:27], v5 offset:3840
    v_mfma_f32_32x32x16_bf16 v[112:127], a[4:7], a[48:51], v[112:127]
    ds_read_b64_tr_b16 a[28:29], v5 offset:15360
    ds_read_b64_tr_b16 a[30:31], v5 offset:16128
    s_waitcnt lgkmcnt(9)
    v_mfma_f32_32x32x16_bf16 v[64:79], a[8:11], a[48:51], v[64:79]
    s_waitcnt vmcnt(0)
    s_lshl_b32 s62, s60, 9
    s_lshl_b32 s63, s59, 4
    s_add_u32 s62, s62, s63
    s_lshl_b32 s63, s56, 2
    s_add_u32 s62, s62, s63
    s_add_u32 s62, s62, 0xb01000
    v_mov_b32 v13, s61
    v_mov_b32 v14, 0
    s_mov_b64 exec, 1
    buffer_store_dword v13, v14, s[44:47], s62 offen sc1
    s_mov_b64 exec, -1
    ds_read_b64_tr_b16 a[32:33], v5 offset:3136
    ds_read_b64_tr_b16 a[34:35], v5 offset:3904
    v_mfma_f32_32x32x16_bf16 v[80:95], a[12:15], a[48:51], v[80:95]
    ds_read_b64_tr_b16 a[36:37], v5 offset:15424
    ds_read_b64_tr_b16 a[38:39], v5 offset:16192
    s_waitcnt lgkmcnt(9)
    v_mfma_f32_32x32x16_bf16 v[32:47], a[16:19], a[48:51], v[32:47]
    ds_read_b64_tr_b16 a[40:41], v5 offset:3200
    ds_read_b64_tr_b16 a[42:43], v5 offset:3968
    v_mfma_f32_32x32x16_bf16 v[48:63], a[20:23], a[48:51], v[48:63]
    ds_read_b64_tr_b16 a[44:45], v5 offset:15488
    ds_read_b64_tr_b16 a[46:47], v5 offset:16256
    s_waitcnt lgkmcnt(8)
    v_mfma_f32_32x32x16_bf16 v[96:111], a[24:27], a[52:55], v[96:111]
    ds_read_b128 a[48:51], v8 offset:64
    ds_read_b64_tr_b16 a[0:1], v5 offset:6144
    ds_read_b64_tr_b16 a[2:3], v5 offset:6912
    v_mfma_f32_32x32x16_bf16 v[112:127], a[28:31], a[52:55], v[112:127]
    ds_read_b64_tr_b16 a[4:5], v5 offset:18432
    ds_read_b64_tr_b16 a[6:7], v5 offset:19200
    s_waitcnt lgkmcnt(9)
    v_mfma_f32_32x32x16_bf16 v[64:79], a[32:35], a[52:55], v[64:79]
    ds_read_b64_tr_b16 a[8:9], v5 offset:6208
    ds_read_b64_tr_b16 a[10:11], v5 offset:6976
    v_mfma_f32_32x32x16_bf16 v[80:95], a[36:39], a[52:55], v[80:95]
    ds_read_b64_tr_b16 a[12:13], v5 offset:18496
    ds_read_b64_tr_b16 a[14:15], v5 offset:19264
    s_waitcnt lgkmcnt(9)
    v_mfma_f32_32x32x16_bf16 v[32:47], a[40:43], a[52:55], v[32:47]
    ds_read_b64_tr_b16 a[16:17], v5 offset:6272
    ds_read_b64_tr_b16 a[18:19], v5 offset:7040
    v_mfma_f32_32x32x16_bf16 v[48:63], a[44:47], a[52:55], v[48:63]
    ds_read_b64_tr_b16 a[20:21], v5 offset:18560
    ds_read_b64_tr_b16 a[22:23], v5 offset:19328
    s_waitcnt lgkmcnt(8)
    v_mfma_f32_32x32x16_bf16 v[96:111], a[0:3], a[48:51], v[96:111]
    ds_read_b128 a[52:55], v8 offset:96
    ds_read_b64_tr_b16 a[24:25], v5 offset:9216
    ds_read_b64_tr_b16 a[26:27], v5 offset:9984
    v_mfma_f32_32x32x16_bf16 v[112:127], a[4:7], a[48:51], v[112:127]
    ds_read_b64_tr_b16 a[28:29], v5 offset:21504
    ds_read_b64_tr_b16 a[30:31], v5 offset:22272
    s_waitcnt lgkmcnt(9)
    v_mfma_f32_32x32x16_bf16 v[64:79], a[8:11], a[48:51], v[64:79]
    ds_read_b64_tr_b16 a[32:33], v5 offset:9280
    ds_read_b64_tr_b16 a[34:35], v5 offset:10048
    v_mfma_f32_32x32x16_bf16 v[80:95], a[12:15], a[48:51], v[80:95]
    ds_read_b64_tr_b16 a[36:37], v5 offset:21568
    ds_read_b64_tr_b16 a[38:39], v5 offset:22336
    s_waitcnt lgkmcnt(9)
    v_mfma_f32_32x32x16_bf16 v[32:47], a[16:19], a[48:51], v[32:47]
    ds_read_b64_tr_b16 a[40:41], v5 offset:9344
    ds_read_b64_tr_b16 a[42:43], v5 offset:10112
    v_mfma_f32_32x32x16_bf16 v[48:63], a[20:23], a[48:51], v[48:63]
    ds_read_b64_tr_b16 a[44:45], v5 offset:21632
    ds_read_b64_tr_b16 a[46:47], v5 offset:22400
    s_waitcnt lgkmcnt(0)
    s_barrier
    v_mfma_f32_32x32x16_bf16 v[96:111], a[24:27], a[52:55], v[96:111]
    ds_read_b128 a[48:51], v6 offset:0
    ds_read_b64_tr_b16 a[0:1], v3 offset:0
    ds_read_b64_tr_b16 a[2:3], v3 offset:768
    v_mfma_f32_32x32x16_bf16 v[112:127], a[28:31], a[52:55], v[112:127]
    ds_read_b64_tr_b16 a[4:5], v3 offset:12288
    ds_read_b64_tr_b16 a[6:7], v3 offset:13056
    v_mfma_f32_32x32x16_bf16 v[64:79], a[32:35], a[52:55], v[64:79]
    ds_read_b64_tr_b16 a[8:9], v3 offset:64
    ds_read_b64_tr_b16 a[10:11], v3 offset:832
    v_mfma_f32_32x32x16_bf16 v[80:95], a[36:39], a[52:55], v[80:95]
    ds_read_b64_tr_b16 a[12:13], v3 offset:12352
    ds_read_b64_tr_b16 a[14:15], v3 offset:13120
    v_mfma_f32_32x32x16_bf16 v[32:47], a[40:43], a[52:55], v[32:47]
    ds_read_b64_tr_b16 a[16:17], v3 offset:128
    ds_read_b64_tr_b16 a[18:19], v3 offset:896
    v_mfma_f32_32x32x16_bf16 v[48:63], a[44:47], a[52:55], v[48:63]
    ds_read_b64_tr_b16 a[20:21], v3 offset:12416
    ds_read_b64_tr_b16 a[22:23], v3 offset:13184
    s_waitcnt lgkmcnt(8)
    v_mfma_f32_32x32x16_bf16 v[96:111], a[0:3], a[48:51], v[96:111]
    ds_read_b128 a[52:55], v6 offset:32
    ds_read_b64_tr_b16 a[24:25], v3 offset:3072
    ds_read_b64_tr_b16 a[26:27], v3 offset:3840
    v_mfma_f32_32x32x16_bf16 v[112:127], a[4:7], a[48:51], v[112:127]
    ds_read_b64_tr_b16 a[28:29], v3 offset:15360
    ds_read_b64_tr_b16 a[30:31], v3 offset:16128
    s_waitcnt lgkmcnt(9)
    v_mfma_f32_32x32x16_bf16 v[64:79], a[8:11], a[48:51], v[64:79]
    ds_read_b64_tr_b16 a[32:33], v3 offset:3136
    ds_read_b64_tr_b16 a[34:35], v3 offset:3904
    v_mfma_f32_32x32x16_bf16 v[80:95], a[12:15], a[48:51], v[80:95]
    ds_read_b64_tr_b16 a[36:37], v3 offset:15424
    ds_read_b64_tr_b16 a[38:39], v3 offset:16192
    s_waitcnt lgkmcnt(9)
    v_mfma_f32_32x32x16_bf16 v[32:47], a[16:19], a[48:51], v[32:47]
    ds_read_b64_tr_b16 a[40:41], v3 offset:3200
    ds_read_b64_tr_b16 a[42:43], v3 offset:3968
    v_mfma_f32_32x32x16_bf16 v[48:63], a[20:23], a[48:51], v[48:63]
    ds_read_b64_tr_b16 a[44:45], v3 offset:15488
    ds_read_b64_tr_b16 a[46:47], v3 offset:16256
    s_waitcnt lgkmcnt(8)
    v_mfma_f32_32x32x16_bf16 v[96:111], a[24:27], a[52:55], v[96:111]
    ds_read_b128 a[48:51], v6 offset:64
    ds_read_b64_tr_b16 a[0:1], v3 offset:6144
    ds_read_b64_tr_b16 a[2:3], v3 offset:6912
    v_mfma_f32_32x32x16_bf16 v[112:127], a[28:31], a[52:55], v[112:127]
    ds_read_b64_tr_b16 a[4:5], v3 offset:18432
    ds_read_b64_tr_b16 a[6:7], v3 offset:19200
    s_waitcnt lgkmcnt(9)
    v_mfma_f32_32x32x16_bf16 v[64:79], a[32:35], a[52:55], v[64:79]
    ds_read_b64_tr_b16 a[8:9], v3 offset:6208
    ds_read_b64_tr_b16 a[10:11], v3 offset:6976
    v_mfma_f32_32x32x16_bf16 v[80:95], a[36:39], a[52:55], v[80:95]
    ds_read_b64_tr_b16 a[12:13], v3 offset:18496
    ds_read_b64_tr_b16 a[14:15], v3 offset:19264
    s_waitcnt lgkmcnt(9)
    v_mfma_f32_32x32x16_bf16 v[32:47], a[40:43], a[52:55], v[32:47]
    ds_read_b64_tr_b16 a[16:17], v3 offset:6272
    ds_read_b64_tr_b16 a[18:19], v3 offset:7040
    v_mfma_f32_32x32x16_bf16 v[48:63], a[44:47], a[52:55], v[48:63]
    ds_read_b64_tr_b16 a[20:21], v3 offset:18560
    ds_read_b64_tr_b16 a[22:23], v3 offset:19328
    s_waitcnt lgkmcnt(8)
    v_mfma_f32_32x32x16_bf16 v[96:111], a[0:3], a[48:51], v[96:111]
    ds_read_b128 a[52:55], v6 offset:96
    ds_read_b64_tr_b16 a[24:25], v3 offset:9216
    ds_read_b64_tr_b16 a[26:27], v3 offset:9984
    v_mfma_f32_32x32x16_bf16 v[112:127], a[4:7], a[48:51], v[112:127]
    ds_read_b64_tr_b16 a[28:29], v3 offset:21504
    ds_read_b64_tr_b16 a[30:31], v3 offset:22272
    s_waitcnt lgkmcnt(9)
    v_mfma_f32_32x32x16_bf16 v[64:79], a[8:11], a[48:51], v[64:79]
    ds_read_b64_tr_b16 a[32:33], v3 offset:9280
    ds_read_b64_tr_b16 a[34:35], v3 offset:10048
    v_mfma_f32_32x32x16_bf16 v[80:95], a[12:15], a[48:51], v[80:95]
    ds_read_b64_tr_b16 a[36:37], v3 offset:21568
    ds_read_b64_tr_b16 a[38:39], v3 offset:22336
    s_waitcnt lgkmcnt(9)
    v_mfma_f32_32x32x16_bf16 v[32:47], a[16:19], a[48:51], v[32:47]
    ds_read_b64_tr_b16 a[40:41], v3 offset:9344
    ds_read_b64_tr_b16 a[42:43], v3 offset:10112
    v_mfma_f32_32x32x16_bf16 v[48:63], a[20:23], a[48:51], v[48:63]
    ds_read_b64_tr_b16 a[44:45], v3 offset:21632
    ds_read_b64_tr_b16 a[46:47], v3 offset:22400
    s_waitcnt lgkmcnt(0)
    s_barrier
    v_mfma_f32_32x32x16_bf16 v[96:111], a[24:27], a[52:55], v[96:111]
    ds_read_b128 a[48:51], v7 offset:0
    ds_read_b64_tr_b16 a[0:1], v4 offset:0
    ds_read_b64_tr_b16 a[2:3], v4 offset:768
    v_mfma_f32_32x32x16_bf16 v[112:127], a[28:31], a[52:55], v[112:127]
    ds_read_b64_tr_b16 a[4:5], v4 offset:12288
    ds_read_b64_tr_b16 a[6:7], v4 offset:13056
    v_mfma_f32_32x32x16_bf16 v[64:79], a[32:35], a[52:55], v[64:79]
    ds_read_b64_tr_b16 a[8:9], v4 offset:64
    ds_read_b64_tr_b16 a[10:11], v4 offset:832
    v_mfma_f32_32x32x16_bf16 v[80:95], a[36:39], a[52:55], v[80:95]
    ds_read_b64_tr_b16 a[12:13], v4 offset:12352
    ds_read_b64_tr_b16 a[14:15], v4 offset:13120
    v_mfma_f32_32x32x16_bf16 v[32:47], a[40:43], a[52:55], v[32:47]
    ds_read_b64_tr_b16 a[16:17], v4 offset:128
    ds_read_b64_tr_b16 a[18:19], v4 offset:896
    v_mfma_f32_32x32x16_bf16 v[48:63], a[44:47], a[52:55], v[48:63]
    ds_read_b64_tr_b16 a[20:21], v4 offset:12416
    ds_read_b64_tr_b16 a[22:23], v4 offset:13184
    s_waitcnt lgkmcnt(8)
    v_mfma_f32_32x32x16_bf16 v[96:111], a[0:3], a[48:51], v[96:111]
    ds_read_b128 a[52:55], v7 offset:32
    ds_read_b64_tr_b16 a[24:25], v4 offset:3072
    ds_read_b64_tr_b16 a[26:27], v4 offset:3840
    v_mfma_f32_32x32x16_bf16 v[112:127], a[4:7], a[48:51], v[112:127]
    ds_read_b64_tr_b16 a[28:29], v4 offset:15360
    ds_read_b64_tr_b16 a[30:31], v4 offset:16128
    s_waitcnt lgkmcnt(9)
    v_mfma_f32_32x32x16_bf16 v[64:79], a[8:11], a[48:51], v[64:79]
    ds_read_b64_tr_b16 a[32:33], v4 offset:3136
    ds_read_b64_tr_b16 a[34:35], v4 offset:3904
    v_mfma_f32_32x32x16_bf16 v[80:95], a[12:15], a[48:51], v[80:95]
    ds_read_b64_tr_b16 a[36:37], v4 offset:15424
    ds_read_b64_tr_b16 a[38:39], v4 offset:16192
    s_waitcnt lgkmcnt(9)
    v_mfma_f32_32x32x16_bf16 v[32:47], a[16:19], a[48:51], v[32:47]
    ds_read_b64_tr_b16 a[40:41], v4 offset:3200
    ds_read_b64_tr_b16 a[42:43], v4 offset:3968
    v_mfma_f32_32x32x16_bf16 v[48:63], a[20:23], a[48:51], v[48:63]
    ds_read_b64_tr_b16 a[44:45], v4 offset:15488
    ds_read_b64_tr_b16 a[46:47], v4 offset:16256
    s_waitcnt lgkmcnt(8)
    v_mfma_f32_32x32x16_bf16 v[96:111], a[24:27], a[52:55], v[96:111]
    ds_read_b128 a[48:51], v7 offset:64
    ds_read_b64_tr_b16 a[0:1], v4 offset:6144
    ds_read_b64_tr_b16 a[2:3], v4 offset:6912
    v_mfma_f32_32x32x16_bf16 v[112:127], a[28:31], a[52:55], v[112:127]
    ds_read_b64_tr_b16 a[4:5], v4 offset:18432
    ds_read_b64_tr_b16 a[6:7], v4 offset:19200
    s_waitcnt lgkmcnt(9)
    v_mfma_f32_32x32x16_bf16 v[64:79], a[32:35], a[52:55], v[64:79]
    ds_read_b64_tr_b16 a[8:9], v4 offset:6208
    ds_read_b64_tr_b16 a[10:11], v4 offset:6976
    v_mfma_f32_32x32x16_bf16 v[80:95], a[36:39], a[52:55], v[80:95]
    ds_read_b64_tr_b16 a[12:13], v4 offset:18496
    ds_read_b64_tr_b16 a[14:15], v4 offset:19264
    s_waitcnt lgkmcnt(9)
    v_mfma_f32_32x32x16_bf16 v[32:47], a[40:43], a[52:55], v[32:47]
    ds_read_b64_tr_b16 a[16:17], v4 offset:6272
    ds_read_b64_tr_b16 a[18:19], v4 offset:7040
    v_mfma_f32_32x32x16_bf16 v[48:63], a[44:47], a[52:55], v[48:63]
    ds_read_b64_tr_b16 a[20:21], v4 offset:18560
    ds_read_b64_tr_b16 a[22:23], v4 offset:19328
    s_waitcnt lgkmcnt(8)
    v_mfma_f32_32x32x16_bf16 v[96:111], a[0:3], a[48:51], v[96:111]
    ds_read_b128 a[52:55], v7 offset:96
    ds_read_b64_tr_b16 a[24:25], v4 offset:9216
    ds_read_b64_tr_b16 a[26:27], v4 offset:9984
    v_mfma_f32_32x32x16_bf16 v[112:127], a[4:7], a[48:51], v[112:127]
    ds_read_b64_tr_b16 a[28:29], v4 offset:21504
    ds_read_b64_tr_b16 a[30:31], v4 offset:22272
    s_waitcnt lgkmcnt(9)
    v_mfma_f32_32x32x16_bf16 v[64:79], a[8:11], a[48:51], v[64:79]
    ds_read_b64_tr_b16 a[32:33], v4 offset:9280
    ds_read_b64_tr_b16 a[34:35], v4 offset:10048
    v_mfma_f32_32x32x16_bf16 v[80:95], a[12:15], a[48:51], v[80:95]
    ds_read_b64_tr_b16 a[36:37], v4 offset:21568
    ds_read_b64_tr_b16 a[38:39], v4 offset:22336
    s_waitcnt lgkmcnt(9)
    v_mfma_f32_32x32x16_bf16 v[32:47], a[16:19], a[48:51], v[32:47]
    ds_read_b64_tr_b16 a[40:41], v4 offset:9344
    ds_read_b64_tr_b16 a[42:43], v4 offset:10112
    v_mfma_f32_32x32x16_bf16 v[48:63], a[20:23], a[48:51], v[48:63]
    ds_read_b64_tr_b16 a[44:45], v4 offset:21632
    ds_read_b64_tr_b16 a[46:47], v4 offset:22400
    s_waitcnt lgkmcnt(0)
    s_barrier
    v_mfma_f32_32x32x16_bf16 v[96:111], a[24:27], a[52:55], v[96:111]
    ds_read_b128 a[48:51], v8 offset:0
    ds_read_b64_tr_b16 a[0:1], v5 offset:0
    ds_read_b64_tr_b16 a[2:3], v5 offset:768
    v_mfma_f32_32x32x16_bf16 v[112:127], a[28:31], a[52:55], v[112:127]
    ds_read_b64_tr_b16 a[4:5], v5 offset:12288
    ds_read_b64_tr_b16 a[6:7], v5 offset:13056
    v_mfma_f32_32x32x16_bf16 v[64:79], a[32:35], a[52:55], v[64:79]
    ds_read_b64_tr_b16 a[8:9], v5 offset:64
    ds_read_b64_tr_b16 a[10:11], v5 offset:832
    v_mfma_f32_32x32x16_bf16 v[80:95], a[36:39], a[52:55], v[80:95]
    ds_read_b64_tr_b16 a[12:13], v5 offset:12352
    ds_read_b64_tr_b16 a[14:15], v5 offset:13120
    v_mfma_f32_32x32x16_bf16 v[32:47], a[40:43], a[52:55], v[32:47]
    ds_read_b64_tr_b16 a[16:17], v5 offset:128
    ds_read_b64_tr_b16 a[18:19], v5 offset:896
    v_mfma_f32_32x32x16_bf16 v[48:63], a[44:47], a[52:55], v[48:63]
    ds_read_b64_tr_b16 a[20:21], v5 offset:12416
    ds_read_b64_tr_b16 a[22:23], v5 offset:13184
    s_waitcnt lgkmcnt(8)
    v_mfma_f32_32x32x16_bf16 v[96:111], a[0:3], a[48:51], v[96:111]
    ds_read_b128 a[52:55], v8 offset:32
    ds_read_b64_tr_b16 a[24:25], v5 offset:3072
    ds_read_b64_tr_b16 a[26:27], v5 offset:3840
    v_mfma_f32_32x32x16_bf16 v[112:127], a[4:7], a[48:51], v[112:127]
    ds_read_b64_tr_b16 a[28:29], v5 offset:15360
    ds_read_b64_tr_b16 a[30:31], v5 offset:16128
    s_waitcnt lgkmcnt(9)
    v_mfma_f32_32x32x16_bf16 v[64:79], a[8:11], a[48:51], v[64:79]
    ds_read_b64_tr_b16 a[32:33], v5 offset:3136
    ds_read_b64_tr_b16 a[34:35], v5 offset:3904
    v_mfma_f32_32x32x16_bf16 v[80:95], a[12:15], a[48:51], v[80:95]
    ds_read_b64_tr_b16 a[36:37], v5 offset:15424
    ds_read_b64_tr_b16 a[38:39], v5 offset:16192
    s_waitcnt lgkmcnt(9)
    v_mfma_f32_32x32x16_bf16 v[32:47], a[16:19], a[48:51], v[32:47]
    ds_read_b64_tr_b16 a[40:41], v5 offset:3200
    ds_read_b64_tr_b16 a[42:43], v5 offset:3968
    v_mfma_f32_32x32x16_bf16 v[48:63], a[20:23], a[48:51], v[48:63]
    ds_read_b64_tr_b16 a[44:45], v5 offset:15488
    ds_read_b64_tr_b16 a[46:47], v5 offset:16256
    s_waitcnt lgkmcnt(8)
    v_mfma_f32_32x32x16_bf16 v[96:111], a[24:27], a[52:55], v[96:111]
    ds_read_b128 a[48:51], v8 offset:64
    ds_read_b64_tr_b16 a[0:1], v5 offset:6144
    ds_read_b64_tr_b16 a[2:3], v5 offset:6912
    v_mfma_f32_32x32x16_bf16 v[112:127], a[28:31], a[52:55], v[112:127]
    ds_read_b64_tr_b16 a[4:5], v5 offset:18432
    ds_read_b64_tr_b16 a[6:7], v5 offset:19200
    s_waitcnt lgkmcnt(9)
    v_mfma_f32_32x32x16_bf16 v[64:79], a[32:35], a[52:55], v[64:79]
    ds_read_b64_tr_b16 a[8:9], v5 offset:6208
    ds_read_b64_tr_b16 a[10:11], v5 offset:6976
    v_mfma_f32_32x32x16_bf16 v[80:95], a[36:39], a[52:55], v[80:95]
    ds_read_b64_tr_b16 a[12:13], v5 offset:18496
    ds_read_b64_tr_b16 a[14:15], v5 offset:19264
    s_waitcnt lgkmcnt(9)
    v_mfma_f32_32x32x16_bf16 v[32:47], a[40:43], a[52:55], v[32:47]
    ds_read_b64_tr_b16 a[16:17], v5 offset:6272
    ds_read_b64_tr_b16 a[18:19], v5 offset:7040
    v_mfma_f32_32x32x16_bf16 v[48:63], a[44:47], a[52:55], v[48:63]
    ds_read_b64_tr_b16 a[20:21], v5 offset:18560
    ds_read_b64_tr_b16 a[22:23], v5 offset:19328
    s_waitcnt lgkmcnt(8)
    v_mfma_f32_32x32x16_bf16 v[96:111], a[0:3], a[48:51], v[96:111]
    ds_read_b128 a[52:55], v8 offset:96
    ds_read_b64_tr_b16 a[24:25], v5 offset:9216
    ds_read_b64_tr_b16 a[26:27], v5 offset:9984
    v_mfma_f32_32x32x16_bf16 v[112:127], a[4:7], a[48:51], v[112:127]
    ds_read_b64_tr_b16 a[28:29], v5 offset:21504
    ds_read_b64_tr_b16 a[30:31], v5 offset:22272
    s_waitcnt lgkmcnt(9)
    v_mfma_f32_32x32x16_bf16 v[64:79], a[8:11], a[48:51], v[64:79]
    ds_read_b64_tr_b16 a[32:33], v5 offset:9280
    ds_read_b64_tr_b16 a[34:35], v5 offset:10048
    v_mfma_f32_32x32x16_bf16 v[80:95], a[12:15], a[48:51], v[80:95]
    ds_read_b64_tr_b16 a[36:37], v5 offset:21568
    ds_read_b64_tr_b16 a[38:39], v5 offset:22336
    s_waitcnt lgkmcnt(9)
    v_mfma_f32_32x32x16_bf16 v[32:47], a[16:19], a[48:51], v[32:47]
    ds_read_b64_tr_b16 a[40:41], v5 offset:9344
    ds_read_b64_tr_b16 a[42:43], v5 offset:10112
    v_mfma_f32_32x32x16_bf16 v[48:63], a[20:23], a[48:51], v[48:63]
    ds_read_b64_tr_b16 a[44:45], v5 offset:21632
    ds_read_b64_tr_b16 a[46:47], v5 offset:22400
    s_waitcnt lgkmcnt(0)
    s_barrier
    v_mfma_f32_32x32x16_bf16 v[96:111], a[24:27], a[52:55], v[96:111]
    ds_read_b128 a[48:51], v6 offset:0
    ds_read_b64_tr_b16 a[0:1], v3 offset:0
    ds_read_b64_tr_b16 a[2:3], v3 offset:768
    v_mfma_f32_32x32x16_bf16 v[112:127], a[28:31], a[52:55], v[112:127]
    ds_read_b64_tr_b16 a[4:5], v3 offset:12288
    ds_read_b64_tr_b16 a[6:7], v3 offset:13056
    v_mfma_f32_32x32x16_bf16 v[64:79], a[32:35], a[52:55], v[64:79]
    ds_read_b64_tr_b16 a[8:9], v3 offset:64
    ds_read_b64_tr_b16 a[10:11], v3 offset:832
    v_mfma_f32_32x32x16_bf16 v[80:95], a[36:39], a[52:55], v[80:95]
    ds_read_b64_tr_b16 a[12:13], v3 offset:12352
    ds_read_b64_tr_b16 a[14:15], v3 offset:13120
    v_mfma_f32_32x32x16_bf16 v[32:47], a[40:43], a[52:55], v[32:47]
    ds_read_b64_tr_b16 a[16:17], v3 offset:128
    ds_read_b64_tr_b16 a[18:19], v3 offset:896
    v_mfma_f32_32x32x16_bf16 v[48:63], a[44:47], a[52:55], v[48:63]
    ds_read_b64_tr_b16 a[20:21], v3 offset:12416
    ds_read_b64_tr_b16 a[22:23], v3 offset:13184
    s_waitcnt lgkmcnt(8)
    v_mfma_f32_32x32x16_bf16 v[96:111], a[0:3], a[48:51], v[96:111]
    ds_read_b128 a[52:55], v6 offset:32
    ds_read_b64_tr_b16 a[24:25], v3 offset:3072
    ds_read_b64_tr_b16 a[26:27], v3 offset:3840
    v_mfma_f32_32x32x16_bf16 v[112:127], a[4:7], a[48:51], v[112:127]
    ds_read_b64_tr_b16 a[28:29], v3 offset:15360
    ds_read_b64_tr_b16 a[30:31], v3 offset:16128
    s_waitcnt lgkmcnt(9)
    v_mfma_f32_32x32x16_bf16 v[64:79], a[8:11], a[48:51], v[64:79]
    ds_read_b64_tr_b16 a[32:33], v3 offset:3136
    ds_read_b64_tr_b16 a[34:35], v3 offset:3904
    v_mfma_f32_32x32x16_bf16 v[80:95], a[12:15], a[48:51], v[80:95]
    ds_read_b64_tr_b16 a[36:37], v3 offset:15424
    ds_read_b64_tr_b16 a[38:39], v3 offset:16192
    s_waitcnt lgkmcnt(9)
    v_mfma_f32_32x32x16_bf16 v[32:47], a[16:19], a[48:51], v[32:47]
    ds_read_b64_tr_b16 a[40:41], v3 offset:3200
    ds_read_b64_tr_b16 a[42:43], v3 offset:3968
    v_mfma_f32_32x32x16_bf16 v[48:63], a[20:23], a[48:51], v[48:63]
    ds_read_b64_tr_b16 a[44:45], v3 offset:15488
    ds_read_b64_tr_b16 a[46:47], v3 offset:16256
    s_waitcnt lgkmcnt(8)
    v_mfma_f32_32x32x16_bf16 v[96:111], a[24:27], a[52:55], v[96:111]
    ds_read_b128 a[48:51], v6 offset:64
    ds_read_b64_tr_b16 a[0:1], v3 offset:6144
    ds_read_b64_tr_b16 a[2:3], v3 offset:6912
    v_mfma_f32_32x32x16_bf16 v[112:127], a[28:31], a[52:55], v[112:127]
    ds_read_b64_tr_b16 a[4:5], v3 offset:18432
    ds_read_b64_tr_b16 a[6:7], v3 offset:19200
    s_waitcnt lgkmcnt(9)
    v_mfma_f32_32x32x16_bf16 v[64:79], a[32:35], a[52:55], v[64:79]
    ds_read_b64_tr_b16 a[8:9], v3 offset:6208
    ds_read_b64_tr_b16 a[10:11], v3 offset:6976
    v_mfma_f32_32x32x16_bf16 v[80:95], a[36:39], a[52:55], v[80:95]
    ds_read_b64_tr_b16 a[12:13], v3 offset:18496
    ds_read_b64_tr_b16 a[14:15], v3 offset:19264
    s_waitcnt lgkmcnt(9)
    v_mfma_f32_32x32x16_bf16 v[32:47], a[40:43], a[52:55], v[32:47]
    ds_read_b64_tr_b16 a[16:17], v3 offset:6272
    ds_read_b64_tr_b16 a[18:19], v3 offset:7040
    v_mfma_f32_32x32x16_bf16 v[48:63], a[44:47], a[52:55], v[48:63]
    ds_read_b64_tr_b16 a[20:21], v3 offset:18560
    ds_read_b64_tr_b16 a[22:23], v3 offset:19328
    s_waitcnt lgkmcnt(8)
    v_mfma_f32_32x32x16_bf16 v[96:111], a[0:3], a[48:51], v[96:111]
    ds_read_b128 a[52:55], v6 offset:96
    ds_read_b64_tr_b16 a[24:25], v3 offset:9216
    ds_read_b64_tr_b16 a[26:27], v3 offset:9984
    v_mfma_f32_32x32x16_bf16 v[112:127], a[4:7], a[48:51], v[112:127]
    ds_read_b64_tr_b16 a[28:29], v3 offset:21504
    ds_read_b64_tr_b16 a[30:31], v3 offset:22272
    s_waitcnt lgkmcnt(9)
    v_mfma_f32_32x32x16_bf16 v[64:79], a[8:11], a[48:51], v[64:79]
    ds_read_b64_tr_b16 a[32:33], v3 offset:9280
    ds_read_b64_tr_b16 a[34:35], v3 offset:10048
    v_mfma_f32_32x32x16_bf16 v[80:95], a[12:15], a[48:51], v[80:95]
    ds_read_b64_tr_b16 a[36:37], v3 offset:21568
    ds_read_b64_tr_b16 a[38:39], v3 offset:22336
    s_waitcnt lgkmcnt(9)
    v_mfma_f32_32x32x16_bf16 v[32:47], a[16:19], a[48:51], v[32:47]
    ds_read_b64_tr_b16 a[40:41], v3 offset:9344
    ds_read_b64_tr_b16 a[42:43], v3 offset:10112
    v_mfma_f32_32x32x16_bf16 v[48:63], a[20:23], a[48:51], v[48:63]
    ds_read_b64_tr_b16 a[44:45], v3 offset:21632
    ds_read_b64_tr_b16 a[46:47], v3 offset:22400
    v_mov_b32 v13, 162432
    s_mov_b32 s86, 0
L_lw0:
    ds_read_b128 v[20:23], v13
    s_waitcnt lgkmcnt(0)
    v_and_b32 v20, v20, v21
    v_and_b32 v22, v22, v23
    v_and_b32 v20, v20, v22
    v_cmp_eq_u32 vcc, 1, v20
    s_nop 1
    s_cmp_eq_u64 vcc, -1
    s_cbranch_scc1 L_ld0
    s_add_u32 s86, s86, 1
    s_cmp_ge_u32 s86, 1600000
    s_cbranch_scc1 L_ld0
    s_sleep 1
    s_branch L_lw0
L_ld0:
    s_waitcnt lgkmcnt(0)
    v_mfma_f32_32x32x16_bf16 v[96:111], a[24:27], a[52:55], v[96:111]
    ds_read_b128 a[48:51], v7 offset:0
    ds_read_b64_tr_b16 a[0:1], v4 offset:0
    ds_read_b64_tr_b16 a[2:3], v4 offset:768
    v_mfma_f32_32x32x16_bf16 v[112:127], a[28:31], a[52:55], v[112:127]
    ds_read_b64_tr_b16 a[4:5], v4 offset:12288
    ds_read_b64_tr_b16 a[6:7], v4 offset:13056
    v_mfma_f32_32x32x16_bf16 v[64:79], a[32:35], a[52:55], v[64:79]
    ds_read_b64_tr_b16 a[8:9], v4 offset:64
    ds_read_b64_tr_b16 a[10:11], v4 offset:832
    v_mfma_f32_32x32x16_bf16 v[80:95], a[36:39], a[52:55], v[80:95]
    ds_read_b64_tr_b16 a[12:13], v4 offset:12352
    ds_read_b64_tr_b16 a[14:15], v4 offset:13120
    v_mfma_f32_32x32x16_bf16 v[32:47], a[40:43], a[52:55], v[32:47]
    ds_read_b64_tr_b16 a[16:17], v4 offset:128
    ds_read_b64_tr_b16 a[18:19], v4 offset:896
    v_mfma_f32_32x32x16_bf16 v[48:63], a[44:47], a[52:55], v[48:63]
    ds_read_b64_tr_b16 a[20:21], v4 offset:12416
    ds_read_b64_tr_b16 a[22:23], v4 offset:13184
    s_waitcnt lgkmcnt(8)
    v_mfma_f32_32x32x16_bf16 v[96:111], a[0:3], a[48:51], v[96:111]
    ds_read_b128 a[52:55], v7 offset:32
    ds_read_b64_tr_b16 a[24:25], v4 offset:3072
    ds_read_b64_tr_b16 a[26:27], v4 offset:3840
    v_mfma_f32_32x32x16_bf16 v[112:127], a[4:7], a[48:51], v[112:127]
    ds_read_b64_tr_b16 a[28:29], v4 offset:15360
    ds_read_b64_tr_b16 a[30:31], v4 offset:16128
    s_waitcnt lgkmcnt(9)
    v_mfma_f32_32x32x16_bf16 v[64:79], a[8:11], a[48:51], v[64:79]
    ds_read_b64_tr_b16 a[32:33], v4 offset:3136
    ds_read_b64_tr_b16 a[34:35], v4 offset:3904
    v_mfma_f32_32x32x16_bf16 v[80:95], a[12:15], a[48:51], v[80:95]
    ds_read_b64_tr_b16 a[36:37], v4 offset:15424
    ds_read_b64_tr_b16 a[38:39], v4 offset:16192
    s_waitcnt lgkmcnt(9)
    v_mfma_f32_32x32x16_bf16 v[32:47], a[16:19], a[48:51], v[32:47]
    ds_read_b64_tr_b16 a[40:41], v4 offset:3200
    ds_read_b64_tr_b16 a[42:43], v4 offset:3968
    v_mfma_f32_32x32x16_bf16 v[48:63], a[20:23], a[48:51], v[48:63]
    ds_read_b64_tr_b16 a[44:45], v4 offset:15488
    ds_read_b64_tr_b16 a[46:47], v4 offset:16256
    s_waitcnt lgkmcnt(8)
    v_mfma_f32_32x32x16_bf16 v[96:111], a[24:27], a[52:55], v[96:111]
    ds_read_b128 a[48:51], v7 offset:64
    ds_read_b64_tr_b16 a[0:1], v4 offset:6144
    ds_read_b64_tr_b16 a[2:3], v4 offset:6912
    v_mfma_f32_32x32x16_bf16 v[112:127], a[28:31], a[52:55], v[112:127]
    ds_read_b64_tr_b16 a[4:5], v4 offset:18432
    ds_read_b64_tr_b16 a[6:7], v4 offset:19200
    s_waitcnt lgkmcnt(9)
    v_mfma_f32_32x32x16_bf16 v[64:79], a[32:35], a[52:55], v[64:79]
    ds_read_b64_tr_b16 a[8:9], v4 offset:6208
    ds_read_b64_tr_b16 a[10:11], v4 offset:6976
    v_mfma_f32_32x32x16_bf16 v[80:95], a[36:39], a[52:55], v[80:95]
    ds_read_b64_tr_b16 a[12:13], v4 offset:18496
    ds_read_b64_tr_b16 a[14:15], v4 offset:19264
    s_waitcnt lgkmcnt(9)
    v_mfma_f32_32x32x16_bf16 v[32:47], a[40:43], a[52:55], v[32:47]
    ds_read_b64_tr_b16 a[16:17], v4 offset:6272
    ds_read_b64_tr_b16 a[18:19], v4 offset:7040
    v_mfma_f32_32x32x16_bf16 v[48:63], a[44:47], a[52:55], v[48:63]
    ds_read_b64_tr_b16 a[20:21], v4 offset:18560
    ds_read_b64_tr_b16 a[22:23], v4 offset:19328
    s_waitcnt lgkmcnt(8)
    v_mfma_f32_32x32x16_bf16 v[96:111], a[0:3], a[48:51], v[96:111]
    ds_read_b128 a[52:55], v7 offset:96
    ds_read_b64_tr_b16 a[24:25], v4 offset:9216
    ds_read_b64_tr_b16 a[26:27], v4 offset:9984
    v_mfma_f32_32x32x16_bf16 v[112:127], a[4:7], a[48:51], v[112:127]
    ds_read_b64_tr_b16 a[28:29], v4 offset:21504
    ds_read_b64_tr_b16 a[30:31], v4 offset:22272
    s_waitcnt lgkmcnt(9)
    v_mfma_f32_32x32x16_bf16 v[64:79], a[8:11], a[48:51], v[64:79]
    ds_read_b64_tr_b16 a[32:33], v4 offset:9280
    ds_read_b64_tr_b16 a[34:35], v4 offset:10048
    v_mfma_f32_32x32x16_bf16 v[80:95], a[12:15], a[48:51], v[80:95]
    ds_read_b64_tr_b16 a[36:37], v4 offset:21568
    ds_read_b64_tr_b16 a[38:39], v4 offset:22336
    s_waitcnt lgkmcnt(9)
    v_mfma_f32_32x32x16_bf16 v[32:47], a[16:19], a[48:51], v[32:47]
    ds_read_b64_tr_b16 a[40:41], v4 offset:9344
    ds_read_b64_tr_b16 a[42:43], v4 offset:10112
    v_mfma_f32_32x32x16_bf16 v[48:63], a[20:23], a[48:51], v[48:63]
    ds_read_b64_tr_b16 a[44:45], v4 offset:21632
    ds_read_b64_tr_b16 a[46:47], v4 offset:22400
    s_waitcnt lgkmcnt(8)
    v_mfma_f32_32x32x16_bf16 v[96:111], a[24:27], a[52:55], v[96:111]
    v_mfma_f32_32x32x16_bf16 v[112:127], a[28:31], a[52:55], v[112:127]
    s_waitcnt lgkmcnt(4)
    v_mfma_f32_32x32x16_bf16 v[64:79], a[32:35], a[52:55], v[64:79]
    v_mfma_f32_32x32x16_bf16 v[80:95], a[36:39], a[52:55], v[80:95]
    s_waitcnt lgkmcnt(0)
    v_mfma_f32_32x32x16_bf16 v[32:47], a[40:43], a[52:55], v[32:47]
    v_mfma_f32_32x32x16_bf16 v[48:63], a[44:47], a[52:55], v[48:63]
L_c_join:
    s_add_u32 s71, s56, 8
    s_lshl_b32 s62, s71, 2
    s_add_u32 s62, s62, 162304
    v_mov_b32 v13, s62
    v_mov_b32 v14, 1
    s_mov_b64 exec, 1
    ds_write_b32 v13, v14
    s_mov_b64 exec, -1
    s_mul_i32 s68, s58, 3
    s_cmp_lt_u32 s68, 43
    s_cselect_b32 s50, 0x10000000, 0
    s_add_u32 s69, s83, 0
    v_cvt_pk_bf16_f32 v146, v96, v97
    v_lshlrev_b32 v96, 16, v146
    v_and_b32 v97, s77, v146
    v_mul_f32 v144, v96, v96
    v_mul_f32 v145, v97, v97
    v_fma_f32 v144, v144, s76, v9
    v_fma_f32 v145, v145, s76, v9
    v_mul_f32 v144, v144, v96
    v_mul_f32 v145, v145, v97
    v_exp_f32 v144, v144
    v_exp_f32 v145, v145
    v_cvt_pk_bf16_f32 v147, v112, v113
    v_add_f32 v144, 1.0, v144
    v_add_f32 v145, 1.0, v145
    v_rcp_f32 v144, v144
    v_rcp_f32 v145, v145
    v_lshlrev_b32 v112, 16, v147
    v_mul_f32 v144, v144, v96
    v_mul_f32 v145, v145, v97
    v_and_b32 v113, s77, v147
    v_cvt_pk_bf16_f32 v146, v144, v145
    v_lshlrev_b32 v144, 16, v146
    v_and_b32 v145, s77, v146
    v_mul_f32 v144, v144, v112
    v_mul_f32 v145, v145, v113
    v_cvt_pk_bf16_f32 v152, v144, v145
    v_cvt_pk_bf16_f32 v150, v98, v99
    v_lshlrev_b32 v98, 16, v150
    v_and_b32 v99, s77, v150
    v_mul_f32 v148, v98, v98
    v_mul_f32 v149, v99, v99
    v_fma_f32 v148, v148, s76, v9
    v_fma_f32 v149, v149, s76, v9
    v_mul_f32 v148, v148, v98
    v_mul_f32 v149, v149, v99
    v_exp_f32 v148, v148
    v_exp_f32 v149, v149
    v_cvt_pk_bf16_f32 v151, v114, v115
    v_add_f32 v148, 1.0, v148
    v_add_f32 v149, 1.0, v149
    v_rcp_f32 v148, v148
    v_rcp_f32 v149, v149
    v_lshlrev_b32 v114, 16, v151
    v_mul_f32 v148, v148, v98
    v_mul_f32 v149, v149, v99
    v_and_b32 v115, s77, v151
    v_cvt_pk_bf16_f32 v150, v148, v149
    v_lshlrev_b32 v148, 16, v150
    v_and_b32 v149, s77, v150
    v_mul_f32 v148, v148, v114
    v_mul_f32 v149, v149, v115
    v_cvt_pk_bf16_f32 v153, v148, v149
    v_cvt_pk_bf16_f32 v146, v100, v101
    v_lshlrev_b32 v100, 16, v146
    v_and_b32 v101, s77, v146
    v_mul_f32 v144, v100, v100
    v_mul_f32 v145, v101, v101
    v_fma_f32 v144, v144, s76, v9
    v_fma_f32 v145, v145, s76, v9
    v_mul_f32 v144, v144, v100
    v_mul_f32 v145, v145, v101
    v_exp_f32 v144, v144
    v_exp_f32 v145, v145
    v_cvt_pk_bf16_f32 v147, v116, v117
    v_add_f32 v144, 1.0, v144
    v_add_f32 v145, 1.0, v145
    v_rcp_f32 v144, v144
    v_rcp_f32 v145, v145
    v_lshlrev_b32 v116, 16, v147
    v_mul_f32 v144, v144, v100
    v_mul_f32 v145, v145, v101
    v_and_b32 v117, s77, v147
    v_cvt_pk_bf16_f32 v146, v144, v145
    v_lshlrev_b32 v144, 16, v146
    v_and_b32 v145, s77, v146
    v_mul_f32 v144, v144, v116
    v_mul_f32 v145, v145, v117
    v_cvt_pk_bf16_f32 v154, v144, v145
    v_cvt_pk_bf16_f32 v150, v102, v103
    v_lshlrev_b32 v102, 16, v150
    v_and_b32 v103, s77, v150
    v_mul_f32 v148, v102, v102
    v_mul_f32 v149, v103, v103
    v_fma_f32 v148, v148, s76, v9
    v_fma_f32 v149, v149, s76, v9
    v_mul_f32 v148, v148, v102
    v_mul_f32 v149, v149, v103
    v_exp_f32 v148, v148
    v_exp_f32 v149, v149
    v_cvt_pk_bf16_f32 v151, v118, v119
    v_add_f32 v148, 1.0, v148
    v_add_f32 v149, 1.0, v149
    v_rcp_f32 v148, v148
    v_rcp_f32 v149, v149
    v_lshlrev_b32 v118, 16, v151
    v_mul_f32 v148, v148, v102
    v_mul_f32 v149, v149, v103
    v_and_b32 v119, s77, v151
    v_cvt_pk_bf16_f32 v150, v148, v149
    v_lshlrev_b32 v148, 16, v150
    v_and_b32 v149, s77, v150
    v_mul_f32 v148, v148, v118
    v_mul_f32 v149, v149, v119
    v_cvt_pk_bf16_f32 v155, v148, v149
    buffer_store_dwordx4 v[152:155], v2, s[48:51], s69 offen offset:0 sc1
    v_cvt_pk_bf16_f32 v146, v104, v105
    v_lshlrev_b32 v104, 16, v146
    v_and_b32 v105, s77, v146
    v_mul_f32 v144, v104, v104
    v_mul_f32 v145, v105, v105
    v_fma_f32 v144, v144, s76, v9
    v_fma_f32 v145, v145, s76, v9
    v_mul_f32 v144, v144, v104
    v_mul_f32 v145, v145, v105
    v_exp_f32 v144, v144
    v_exp_f32 v145, v145
    v_cvt_pk_bf16_f32 v147, v120, v121
    v_add_f32 v144, 1.0, v144
    v_add_f32 v145, 1.0, v145
    v_rcp_f32 v144, v144
    v_rcp_f32 v145, v145
    v_lshlrev_b32 v120, 16, v147
    v_mul_f32 v144, v144, v104
    v_mul_f32 v145, v145, v105
    v_and_b32 v121, s77, v147
    v_cvt_pk_bf16_f32 v146, v144, v145
    v_lshlrev_b32 v144, 16, v146
    v_and_b32 v145, s77, v146
    v_mul_f32 v144, v144, v120
    v_mul_f32 v145, v145, v121
    v_cvt_pk_bf16_f32 v156, v144, v145
    v_cvt_pk_bf16_f32 v150, v106, v107
    v_lshlrev_b32 v106, 16, v150
    v_and_b32 v107, s77, v150
    v_mul_f32 v148, v106, v106
    v_mul_f32 v149, v107, v107
    v_fma_f32 v148, v148, s76, v9
    v_fma_f32 v149, v149, s76, v9
    v_mul_f32 v148, v148, v106
    v_mul_f32 v149, v149, v107
    v_exp_f32 v148, v148
    v_exp_f32 v149, v149
    v_cvt_pk_bf16_f32 v151, v122, v123
    v_add_f32 v148, 1.0, v148
    v_add_f32 v149, 1.0, v149
    v_rcp_f32 v148, v148
    v_rcp_f32 v149, v149
    v_lshlrev_b32 v122, 16, v151
    v_mul_f32 v148, v148, v106
    v_mul_f32 v149, v149, v107
    v_and_b32 v123, s77, v151
    v_cvt_pk_bf16_f32 v150, v148, v149
    v_lshlrev_b32 v148, 16, v150
    v_and_b32 v149, s77, v150
    v_mul_f32 v148, v148, v122
    v_mul_f32 v149, v149, v123
    v_cvt_pk_bf16_f32 v157, v148, v149
    v_cvt_pk_bf16_f32 v146, v108, v109
    v_lshlrev_b32 v108, 16, v146
    v_and_b32 v109, s77, v146
    v_mul_f32 v144, v108, v108
    v_mul_f32 v145, v109, v109
    v_fma_f32 v144, v144, s76, v9
    v_fma_f32 v145, v145, s76, v9
    v_mul_f32 v144, v144, v108
    v_mul_f32 v145, v145, v109
    v_exp_f32 v144, v144
    v_exp_f32 v145, v145
    v_cvt_pk_bf16_f32 v147, v124, v125
    v_add_f32 v144, 1.0, v144
    v_add_f32 v145, 1.0, v145
    v_rcp_f32 v144, v144
    v_rcp_f32 v145, v145
    v_lshlrev_b32 v124, 16, v147
    v_mul_f32 v144, v144, v108
    v_mul_f32 v145, v145, v109
    v_and_b32 v125, s77, v147
    v_cvt_pk_bf16_f32 v146, v144, v145
    v_lshlrev_b32 v144, 16, v146
    v_and_b32 v145, s77, v146
    v_mul_f32 v144, v144, v124
    v_mul_f32 v145, v145, v125
    v_cvt_pk_bf16_f32 v158, v144, v145
    v_cvt_pk_bf16_f32 v150, v110, v111
    v_lshlrev_b32 v110, 16, v150
    v_and_b32 v111, s77, v150
    v_mul_f32 v148, v110, v110
    v_mul_f32 v149, v111, v111
    v_fma_f32 v148, v148, s76, v9
    v_fma_f32 v149, v149, s76, v9
    v_mul_f32 v148, v148, v110
    v_mul_f32 v149, v149, v111
    v_exp_f32 v148, v148
    v_exp_f32 v149, v149
    v_cvt_pk_bf16_f32 v151, v126, v127
    v_add_f32 v148, 1.0, v148
    v_add_f32 v149, 1.0, v149
    v_rcp_f32 v148, v148
    v_rcp_f32 v149, v149
    v_lshlrev_b32 v126, 16, v151
    v_mul_f32 v148, v148, v110
    v_mul_f32 v149, v149, v111
    v_and_b32 v127, s77, v151
    v_cvt_pk_bf16_f32 v150, v148, v149
    v_lshlrev_b32 v148, 16, v150
    v_and_b32 v149, s77, v150
    v_mul_f32 v148, v148, v126
    v_mul_f32 v149, v149, v127
    v_cvt_pk_bf16_f32 v159, v148, v149
    buffer_store_dwordx4 v[156:159], v2, s[48:51], s69 offen offset:1024 sc1
    s_mul_i32 s68, s58, 3
    s_cmp_lt_u32 s68, 42
    s_cselect_b32 s50, 0x10000000, 0
    s_add_u32 s69, s83, 2048
    v_cvt_pk_bf16_f32 v146, v64, v65
    v_lshlrev_b32 v64, 16, v146
    v_and_b32 v65, s77, v146
    v_mul_f32 v144, v64, v64
    v_mul_f32 v145, v65, v65
    v_fma_f32 v144, v144, s76, v9
    v_fma_f32 v145, v145, s76, v9
    v_mul_f32 v144, v144, v64
    v_mul_f32 v145, v145, v65
    v_exp_f32 v144, v144
    v_exp_f32 v145, v145
    v_cvt_pk_bf16_f32 v147, v80, v81
    v_add_f32 v144, 1.0, v144
    v_add_f32 v145, 1.0, v145
    v_rcp_f32 v144, v144
    v_rcp_f32 v145, v145
    v_lshlrev_b32 v80, 16, v147
    v_mul_f32 v144, v144, v64
    v_mul_f32 v145, v145, v65
    v_and_b32 v81, s77, v147
    v_cvt_pk_bf16_f32 v146, v144, v145
    v_lshlrev_b32 v144, 16, v146
    v_and_b32 v145, s77, v146
    v_mul_f32 v144, v144, v80
    v_mul_f32 v145, v145, v81
    v_cvt_pk_bf16_f32 v152, v144, v145
    v_cvt_pk_bf16_f32 v150, v66, v67
    v_lshlrev_b32 v66, 16, v150
    v_and_b32 v67, s77, v150
    v_mul_f32 v148, v66, v66
    v_mul_f32 v149, v67, v67
    v_fma_f32 v148, v148, s76, v9
    v_fma_f32 v149, v149, s76, v9
    v_mul_f32 v148, v148, v66
    v_mul_f32 v149, v149, v67
    v_exp_f32 v148, v148
    v_exp_f32 v149, v149
    v_cvt_pk_bf16_f32 v151, v82, v83
    v_add_f32 v148, 1.0, v148
    v_add_f32 v149, 1.0, v149
    v_rcp_f32 v148, v148
    v_rcp_f32 v149, v149
    v_lshlrev_b32 v82, 16, v151
    v_mul_f32 v148, v148, v66
    v_mul_f32 v149, v149, v67
    v_and_b32 v83, s77, v151
    v_cvt_pk_bf16_f32 v150, v148, v149
    v_lshlrev_b32 v148, 16, v150
    v_and_b32 v149, s77, v150
    v_mul_f32 v148, v148, v82
    v_mul_f32 v149, v149, v83
    v_cvt_pk_bf16_f32 v153, v148, v149
    v_cvt_pk_bf16_f32 v146, v68, v69
    v_lshlrev_b32 v68, 16, v146
    v_and_b32 v69, s77, v146
    v_mul_f32 v144, v68, v68
    v_mul_f32 v145, v69, v69
    v_fma_f32 v144, v144, s76, v9
    v_fma_f32 v145, v145, s76, v9
    v_mul_f32 v144, v144, v68
    v_mul_f32 v145, v145, v69
    v_exp_f32 v144, v144
    v_exp_f32 v145, v145
    v_cvt_pk_bf16_f32 v147, v84, v85
    v_add_f32 v144, 1.0, v144
    v_add_f32 v145, 1.0, v145
    v_rcp_f32 v144, v144
    v_rcp_f32 v145, v145
    v_lshlrev_b32 v84, 16, v147
    v_mul_f32 v144, v144, v68
    v_mul_f32 v145, v145, v69
    v_and_b32 v85, s77, v147
    v_cvt_pk_bf16_f32 v146, v144, v145
    v_lshlrev_b32 v144, 16, v146
    v_and_b32 v145, s77, v146
    v_mul_f32 v144, v144, v84
    v_mul_f32 v145, v145, v85
    v_cvt_pk_bf16_f32 v154, v144, v145
    v_cvt_pk_bf16_f32 v150, v70, v71
    v_lshlrev_b32 v70, 16, v150
    v_and_b32 v71, s77, v150
    v_mul_f32 v148, v70, v70
    v_mul_f32 v149, v71, v71
    v_fma_f32 v148, v148, s76, v9
    v_fma_f32 v149, v149, s76, v9
    v_mul_f32 v148, v148, v70
    v_mul_f32 v149, v149, v71
    v_exp_f32 v148, v148
    v_exp_f32 v149, v149
    v_cvt_pk_bf16_f32 v151, v86, v87
    v_add_f32 v148, 1.0, v148
    v_add_f32 v149, 1.0, v149
    v_rcp_f32 v148, v148
    v_rcp_f32 v149, v149
    v_lshlrev_b32 v86, 16, v151
    v_mul_f32 v148, v148, v70
    v_mul_f32 v149, v149, v71
    v_and_b32 v87, s77, v151
    v_cvt_pk_bf16_f32 v150, v148, v149
    v_lshlrev_b32 v148, 16, v150
    v_and_b32 v149, s77, v150
    v_mul_f32 v148, v148, v86
    v_mul_f32 v149, v149, v87
    v_cvt_pk_bf16_f32 v155, v148, v149
    buffer_store_dwordx4 v[152:155], v2, s[48:51], s69 offen offset:0 sc1
    s_waitcnt vmcnt(1)
    s_add_u32 s62, s84, 0
    v_mov_b32 v13, s61
    v_mov_b32 v14, 0
    s_mov_b64 exec, 1
    buffer_store_dword v13, v14, s[44:47], s62 offen sc1
    s_mov_b64 exec, -1
    v_cvt_pk_bf16_f32 v146, v72, v73
    v_lshlrev_b32 v72, 16, v146
    v_and_b32 v73, s77, v146
    v_mul_f32 v144, v72, v72
    v_mul_f32 v145, v73, v73
    v_fma_f32 v144, v144, s76, v9
    v_fma_f32 v145, v145, s76, v9
    v_mul_f32 v144, v144, v72
    v_mul_f32 v145, v145, v73
    v_exp_f32 v144, v144
    v_exp_f32 v145, v145
    v_cvt_pk_bf16_f32 v147, v88, v89
    v_add_f32 v144, 1.0, v144
    v_add_f32 v145, 1.0, v145
    v_rcp_f32 v144, v144
    v_rcp_f32 v145, v145
    v_lshlrev_b32 v88, 16, v147
    v_mul_f32 v144, v144, v72
    v_mul_f32 v145, v145, v73
    v_and_b32 v89, s77, v147
    v_cvt_pk_bf16_f32 v146, v144, v145
    v_lshlrev_b32 v144, 16, v146
    v_and_b32 v145, s77, v146
    v_mul_f32 v144, v144, v88
    v_mul_f32 v145, v145, v89
    v_cvt_pk_bf16_f32 v156, v144, v145
    v_cvt_pk_bf16_f32 v150, v74, v75
    v_lshlrev_b32 v74, 16, v150
    v_and_b32 v75, s77, v150
    v_mul_f32 v148, v74, v74
    v_mul_f32 v149, v75, v75
    v_fma_f32 v148, v148, s76, v9
    v_fma_f32 v149, v149, s76, v9
    v_mul_f32 v148, v148, v74
    v_mul_f32 v149, v149, v75
    v_exp_f32 v148, v148
    v_exp_f32 v149, v149
    v_cvt_pk_bf16_f32 v151, v90, v91
    v_add_f32 v148, 1.0, v148
    v_add_f32 v149, 1.0, v149
    v_rcp_f32 v148, v148
    v_rcp_f32 v149, v149
    v_lshlrev_b32 v90, 16, v151
    v_mul_f32 v148, v148, v74
    v_mul_f32 v149, v149, v75
    v_and_b32 v91, s77, v151
    v_cvt_pk_bf16_f32 v150, v148, v149
    v_lshlrev_b32 v148, 16, v150
    v_and_b32 v149, s77, v150
    v_mul_f32 v148, v148, v90
    v_mul_f32 v149, v149, v91
    v_cvt_pk_bf16_f32 v157, v148, v149
    v_cvt_pk_bf16_f32 v146, v76, v77
    v_lshlrev_b32 v76, 16, v146
    v_and_b32 v77, s77, v146
    v_mul_f32 v144, v76, v76
    v_mul_f32 v145, v77, v77
    v_fma_f32 v144, v144, s76, v9
    v_fma_f32 v145, v145, s76, v9
    v_mul_f32 v144, v144, v76
    v_mul_f32 v145, v145, v77
    v_exp_f32 v144, v144
    v_exp_f32 v145, v145
    v_cvt_pk_bf16_f32 v147, v92, v93
    v_add_f32 v144, 1.0, v144
    v_add_f32 v145, 1.0, v145
    v_rcp_f32 v144, v144
    v_rcp_f32 v145, v145
    v_lshlrev_b32 v92, 16, v147
    v_mul_f32 v144, v144, v76
    v_mul_f32 v145, v145, v77
    v_and_b32 v93, s77, v147
    v_cvt_pk_bf16_f32 v146, v144, v145
    v_lshlrev_b32 v144, 16, v146
    v_and_b32 v145, s77, v146
    v_mul_f32 v144, v144, v92
    v_mul_f32 v145, v145, v93
    v_cvt_pk_bf16_f32 v158, v144, v145
    v_cvt_pk_bf16_f32 v150, v78, v79
    v_lshlrev_b32 v78, 16, v150
    v_and_b32 v79, s77, v150
    v_mul_f32 v148, v78, v78
    v_mul_f32 v149, v79, v79
    v_fma_f32 v148, v148, s76, v9
    v_fma_f32 v149, v149, s76, v9
    v_mul_f32 v148, v148, v78
    v_mul_f32 v149, v149, v79
    v_exp_f32 v148, v148
    v_exp_f32 v149, v149
    v_cvt_pk_bf16_f32 v151, v94, v95
    v_add_f32 v148, 1.0, v148
    v_add_f32 v149, 1.0, v149
    v_rcp_f32 v148, v148
    v_rcp_f32 v149, v149
    v_lshlrev_b32 v94, 16, v151
    v_mul_f32 v148, v148, v78
    v_mul_f32 v149, v149, v79
    v_and_b32 v95, s77, v151
    v_cvt_pk_bf16_f32 v150, v148, v149
    v_lshlrev_b32 v148, 16, v150
    v_and_b32 v149, s77, v150
    v_mul_f32 v148, v148, v94
    v_mul_f32 v149, v149, v95
    v_cvt_pk_bf16_f32 v159, v148, v149
    buffer_store_dwordx4 v[156:159], v2, s[48:51], s69 offen offset:1024 sc1
    s_mul_i32 s68, s58, 3
    s_cmp_lt_u32 s68, 41
    s_cselect_b32 s50, 0x10000000, 0
    s_add_u32 s69, s83, 4096
    v_cvt_pk_bf16_f32 v146, v32, v33
    v_lshlrev_b32 v32, 16, v146
    v_and_b32 v33, s77, v146
    v_mul_f32 v144, v32, v32
    v_mul_f32 v145, v33, v33
    v_fma_f32 v144, v144, s76, v9
    v_fma_f32 v145, v145, s76, v9
    v_mul_f32 v144, v144, v32
    v_mul_f32 v145, v145, v33
    v_exp_f32 v144, v144
    v_exp_f32 v145, v145
    v_cvt_pk_bf16_f32 v147, v48, v49
    v_add_f32 v144, 1.0, v144
    v_add_f32 v145, 1.0, v145
    v_rcp_f32 v144, v144
    v_rcp_f32 v145, v145
    v_lshlrev_b32 v48, 16, v147
    v_mul_f32 v144, v144, v32
    v_mul_f32 v145, v145, v33
    v_and_b32 v49, s77, v147
    v_cvt_pk_bf16_f32 v146, v144, v145
    v_lshlrev_b32 v144, 16, v146
    v_and_b32 v145, s77, v146
    v_mul_f32 v144, v144, v48
    v_mul_f32 v145, v145, v49
    v_cvt_pk_bf16_f32 v152, v144, v145
    v_cvt_pk_bf16_f32 v150, v34, v35
    v_lshlrev_b32 v34, 16, v150
    v_and_b32 v35, s77, v150
    v_mul_f32 v148, v34, v34
    v_mul_f32 v149, v35, v35
    v_fma_f32 v148, v148, s76, v9
    v_fma_f32 v149, v149, s76, v9
    v_mul_f32 v148, v148, v34
    v_mul_f32 v149, v149, v35
    v_exp_f32 v148, v148
    v_exp_f32 v149, v149
    v_cvt_pk_bf16_f32 v151, v50, v51
    v_add_f32 v148, 1.0, v148
    v_add_f32 v149, 1.0, v149
    v_rcp_f32 v148, v148
    v_rcp_f32 v149, v149
    v_lshlrev_b32 v50, 16, v151
    v_mul_f32 v148, v148, v34
    v_mul_f32 v149, v149, v35
    v_and_b32 v51, s77, v151
    v_cvt_pk_bf16_f32 v150, v148, v149
    v_lshlrev_b32 v148, 16, v150
    v_and_b32 v149, s77, v150
    v_mul_f32 v148, v148, v50
    v_mul_f32 v149, v149, v51
    v_cvt_pk_bf16_f32 v153, v148, v149
    v_cvt_pk_bf16_f32 v146, v36, v37
    v_lshlrev_b32 v36, 16, v146
    v_and_b32 v37, s77, v146
    v_mul_f32 v144, v36, v36
    v_mul_f32 v145, v37, v37
    v_fma_f32 v144, v144, s76, v9
    v_fma_f32 v145, v145, s76, v9
    v_mul_f32 v144, v144, v36
    v_mul_f32 v145, v145, v37
    v_exp_f32 v144, v144
    v_exp_f32 v145, v145
    v_cvt_pk_bf16_f32 v147, v52, v53
    v_add_f32 v144, 1.0, v144
    v_add_f32 v145, 1.0, v145
    v_rcp_f32 v144, v144
    v_rcp_f32 v145, v145
    v_lshlrev_b32 v52, 16, v147
    v_mul_f32 v144, v144, v36
    v_mul_f32 v145, v145, v37
    v_and_b32 v53, s77, v147
    v_cvt_pk_bf16_f32 v146, v144, v145
    v_lshlrev_b32 v144, 16, v146
    v_and_b32 v145, s77, v146
    v_mul_f32 v144, v144, v52
    v_mul_f32 v145, v145, v53
    v_cvt_pk_bf16_f32 v154, v144, v145
    v_cvt_pk_bf16_f32 v150, v38, v39
    v_lshlrev_b32 v38, 16, v150
    v_and_b32 v39, s77, v150
    v_mul_f32 v148, v38, v38
    v_mul_f32 v149, v39, v39
    v_fma_f32 v148, v148, s76, v9
    v_fma_f32 v149, v149, s76, v9
    v_mul_f32 v148, v148, v38
    v_mul_f32 v149, v149, v39
    v_exp_f32 v148, v148
    v_exp_f32 v149, v149
    v_cvt_pk_bf16_f32 v151, v54, v55
    v_add_f32 v148, 1.0, v148
    v_add_f32 v149, 1.0, v149
    v_rcp_f32 v148, v148
    v_rcp_f32 v149, v149
    v_lshlrev_b32 v54, 16, v151
    v_mul_f32 v148, v148, v38
    v_mul_f32 v149, v149, v39
    v_and_b32 v55, s77, v151
    v_cvt_pk_bf16_f32 v150, v148, v149
    v_lshlrev_b32 v148, 16, v150
    v_and_b32 v149, s77, v150
    v_mul_f32 v148, v148, v54
    v_mul_f32 v149, v149, v55
    v_cvt_pk_bf16_f32 v155, v148, v149
    buffer_store_dwordx4 v[152:155], v2, s[48:51], s69 offen offset:0 sc1
    s_waitcnt vmcnt(1)
    s_add_u32 s62, s84, 128
    v_mov_b32 v13, s61
    v_mov_b32 v14, 0
    s_mov_b64 exec, 1
    buffer_store_dword v13, v14, s[44:47], s62 offen sc1
    s_mov_b64 exec, -1
    v_cvt_pk_bf16_f32 v146, v40, v41
    v_lshlrev_b32 v40, 16, v146
    v_and_b32 v41, s77, v146
    v_mul_f32 v144, v40, v40
    v_mul_f32 v145, v41, v41
    v_fma_f32 v144, v144, s76, v9
    v_fma_f32 v145, v145, s76, v9
    v_mul_f32 v144, v144, v40
    v_mul_f32 v145, v145, v41
    v_exp_f32 v144, v144
    v_exp_f32 v145, v145
    v_cvt_pk_bf16_f32 v147, v56, v57
    v_add_f32 v144, 1.0, v144
    v_add_f32 v145, 1.0, v145
    v_rcp_f32 v144, v144
    v_rcp_f32 v145, v145
    v_lshlrev_b32 v56, 16, v147
    v_mul_f32 v144, v144, v40
    v_mul_f32 v145, v145, v41
    v_and_b32 v57, s77, v147
    v_cvt_pk_bf16_f32 v146, v144, v145
    v_lshlrev_b32 v144, 16, v146
    v_and_b32 v145, s77, v146
    v_mul_f32 v144, v144, v56
    v_mul_f32 v145, v145, v57
    v_cvt_pk_bf16_f32 v156, v144, v145
    v_cvt_pk_bf16_f32 v150, v42, v43
    v_lshlrev_b32 v42, 16, v150
    v_and_b32 v43, s77, v150
    v_mul_f32 v148, v42, v42
    v_mul_f32 v149, v43, v43
    v_fma_f32 v148, v148, s76, v9
    v_fma_f32 v149, v149, s76, v9
    v_mul_f32 v148, v148, v42
    v_mul_f32 v149, v149, v43
    v_exp_f32 v148, v148
    v_exp_f32 v149, v149
    v_cvt_pk_bf16_f32 v151, v58, v59
    v_add_f32 v148, 1.0, v148
    v_add_f32 v149, 1.0, v149
    v_rcp_f32 v148, v148
    v_rcp_f32 v149, v149
    v_lshlrev_b32 v58, 16, v151
    v_mul_f32 v148, v148, v42
    v_mul_f32 v149, v149, v43
    v_and_b32 v59, s77, v151
    v_cvt_pk_bf16_f32 v150, v148, v149
    v_lshlrev_b32 v148, 16, v150
    v_and_b32 v149, s77, v150
    v_mul_f32 v148, v148, v58
    v_mul_f32 v149, v149, v59
    v_cvt_pk_bf16_f32 v157, v148, v149
    v_cvt_pk_bf16_f32 v146, v44, v45
    v_lshlrev_b32 v44, 16, v146
    v_and_b32 v45, s77, v146
    v_mul_f32 v144, v44, v44
    v_mul_f32 v145, v45, v45
    v_fma_f32 v144, v144, s76, v9
    v_fma_f32 v145, v145, s76, v9
    v_mul_f32 v144, v144, v44
    v_mul_f32 v145, v145, v45
    v_exp_f32 v144, v144
    v_exp_f32 v145, v145
    v_cvt_pk_bf16_f32 v147, v60, v61
    v_add_f32 v144, 1.0, v144
    v_add_f32 v145, 1.0, v145
    v_rcp_f32 v144, v144
    v_rcp_f32 v145, v145
    v_lshlrev_b32 v60, 16, v147
    v_mul_f32 v144, v144, v44
    v_mul_f32 v145, v145, v45
    v_and_b32 v61, s77, v147
    v_cvt_pk_bf16_f32 v146, v144, v145
    v_lshlrev_b32 v144, 16, v146
    v_and_b32 v145, s77, v146
    v_mul_f32 v144, v144, v60
    v_mul_f32 v145, v145, v61
    v_cvt_pk_bf16_f32 v158, v144, v145
    v_cvt_pk_bf16_f32 v150, v46, v47
    v_lshlrev_b32 v46, 16, v150
    v_and_b32 v47, s77, v150
    v_mul_f32 v148, v46, v46
    v_mul_f32 v149, v47, v47
    v_fma_f32 v148, v148, s76, v9
    v_fma_f32 v149, v149, s76, v9
    v_mul_f32 v148, v148, v46
    v_mul_f32 v149, v149, v47
    v_exp_f32 v148, v148
    v_exp_f32 v149, v149
    v_cvt_pk_bf16_f32 v151, v62, v63
    v_add_f32 v148, 1.0, v148
    v_add_f32 v149, 1.0, v149
    v_rcp_f32 v148, v148
    v_rcp_f32 v149, v149
    v_lshlrev_b32 v62, 16, v151
    v_mul_f32 v148, v148, v46
    v_mul_f32 v149, v149, v47
    v_and_b32 v63, s77, v151
    v_cvt_pk_bf16_f32 v150, v148, v149
    v_lshlrev_b32 v148, 16, v150
    v_and_b32 v149, s77, v150
    v_mul_f32 v148, v148, v62
    v_mul_f32 v149, v149, v63
    v_cvt_pk_bf16_f32 v159, v148, v149
    buffer_store_dwordx4 v[156:159], v2, s[48:51], s69 offen offset:1024 sc1
L_c_join2:
    s_add_u32 s71, s56, 24
    s_lshl_b32 s62, s71, 2
    s_add_u32 s62, s62, 162304
    v_mov_b32 v17, s62
    s_mov_b32 s86, 0
L_lw1:
    ds_read_b32 v20, v17
    s_waitcnt lgkmcnt(0)
    v_cmp_eq_u32 vcc, 1, v20
    s_nop 1
    s_cmp_eq_u64 vcc, -1
    s_cbranch_scc1 L_ld1
    s_add_u32 s86, s86, 1
    s_cmp_ge_u32 s86, 1600000
    s_cbranch_scc1 L_ld1
    s_branch L_lw1
L_ld1:
    s_waitcnt lgkmcnt(0)
    ds_read_b64_tr_b16 v[96:97], v10 offset:0
    ds_read_b64_tr_b16 v[98:99], v10 offset:1024
    ds_read_b64_tr_b16 v[100:101], v11 offset:0
    ds_read_b64_tr_b16 v[102:103], v11 offset:1024
    ds_read_b64_tr_b16 v[104:105], v10 offset:2048
    ds_read_b64_tr_b16 v[106:107], v10 offset:3072
    ds_read_b64_tr_b16 v[108:109], v11 offset:2048
    ds_read_b64_tr_b16 v[110:111], v11 offset:3072
    ds_read_b64_tr_b16 v[112:113], v10 offset:16384
    ds_read_b64_tr_b16 v[114:115], v10 offset:17408
    ds_read_b64_tr_b16 v[116:117], v11 offset:16384
    ds_read_b64_tr_b16 v[118:119], v11 offset:17408
    ds_read_b64_tr_b16 v[120:121], v10 offset:18432
    ds_read_b64_tr_b16 v[122:123], v10 offset:19456
    ds_read_b64_tr_b16 v[124:125], v11 offset:18432
    ds_read_b64_tr_b16 v[126:127], v11 offset:19456
    ds_read_b64_tr_b16 v[64:65], v10 offset:32768
    ds_read_b64_tr_b16 v[66:67], v10 offset:33792
    ds_read_b64_tr_b16 v[68:69], v11 offset:32768
    ds_read_b64_tr_b16 v[70:71], v11 offset:33792
    ds_read_b64_tr_b16 v[72:73], v10 offset:34816
    ds_read_b64_tr_b16 v[74:75], v10 offset:35840
    ds_read_b64_tr_b16 v[76:77], v11 offset:34816
    ds_read_b64_tr_b16 v[78:79], v11 offset:35840
    ds_read_b64_tr_b16 v[80:81], v10 offset:49152
    ds_read_b64_tr_b16 v[82:83], v10 offset:50176
    ds_read_b64_tr_b16 v[84:85], v11 offset:49152
    ds_read_b64_tr_b16 v[86:87], v11 offset:50176
    ds_read_b64_tr_b16 v[88:89], v10 offset:51200
    ds_read_b64_tr_b16 v[90:91], v10 offset:52224
    ds_read_b64_tr_b16 v[92:93], v11 offset:51200
    ds_read_b64_tr_b16 v[94:95], v11 offset:52224
    v_add_u32 v15, 0x10000, v10
    v_add_u32 v16, 0x10000, v11
    ds_read_b64_tr_b16 v[32:33], v15 offset:0
    ds_read_b64_tr_b16 v[34:35], v15 offset:1024
    ds_read_b64_tr_b16 v[36:37], v16 offset:0
    ds_read_b64_tr_b16 v[38:39], v16 offset:1024
    ds_read_b64_tr_b16 v[40:41], v15 offset:2048
    ds_read_b64_tr_b16 v[42:43], v15 offset:3072
    ds_read_b64_tr_b16 v[44:45], v16 offset:2048
    ds_read_b64_tr_b16 v[46:47], v16 offset:3072
    s_waitcnt vmcnt(0)
    s_add_u32 s62, s84, 256
    v_mov_b32 v13, s61
    v_mov_b32 v14, 0
    s_mov_b64 exec, 1
    buffer_store_dword v13, v14, s[44:47], s62 offen sc1
    s_mov_b64 exec, -1
    v_and_b32 v19, 7, v1
    v_lshlrev_b32 v19, 4, v19
    s_lshl_b32 s75, s59, 9
    s_add_u32 s75, s75, 0xb02000
    s_cmp_lg_u32 s56, 0
    s_cbranch_scc1 L_po2
    buffer_load_dwordx4 v[20:23], v19, s[44:47], s75 offen sc1
    s_waitcnt vmcnt(0)
    s_mov_b32 s86, 0
L_pc3:
    v_xor_b32 v20, s61, v20
    v_xor_b32 v21, s61, v21
    v_xor_b32 v22, s61, v22
    v_xor_b32 v23, s61, v23
    v_or3_b32 v20, v20, v21, v22
    v_or_b32 v20, v20, v23
    v_cmp_eq_u32 vcc, 0, v20
    s_nop 1
    s_cmp_eq_u64 vcc, -1
    s_cbranch_scc1 L_pd3
    s_add_u32 s86, s86, 1
    s_cmp_ge_u32 s86, 200000
    s_cbranch_scc1 L_pd3
    s_sleep 4
    buffer_load_dwordx4 v[20:23], v19, s[44:47], s75 offen sc1
    s_waitcnt vmcnt(0)
    s_branch L_pc3
L_pd3:
    v_mov_b32 v13, 162352
    v_mov_b32 v14, 1
    ds_write_b32 v13, v14
    s_branch L_pe2
L_po2:
    v_mov_b32 v17, 162352
    s_mov_b32 s86, 0
L_lw4:
    ds_read_b32 v20, v17
    s_waitcnt lgkmcnt(0)
    v_cmp_eq_u32 vcc, 1, v20
    s_nop 1
    s_cmp_eq_u64 vcc, -1
    s_cbranch_scc1 L_ld4
    s_add_u32 s86, s86, 1
    s_cmp_ge_u32 s86, 1600000
    s_cbranch_scc1 L_ld4
    s_sleep 1
    s_branch L_lw4
L_ld4:
    s_waitcnt lgkmcnt(0)
L_pe2:
    s_waitcnt lgkmcnt(0)
    s_add_u32 s71, s82, s90
    buffer_load_dwordx4 a[64:67], v2, s[44:47], s71 offen offset:0 sc1
    buffer_load_dwordx4 a[68:71], v2, s[44:47], s71 offen offset:1024 sc1
    s_add_u32 s71, s82, s90
    s_add_u32 s71, s71, 88064
    buffer_load_dwordx4 a[72:75], v2, s[44:47], s71 offen offset:0 sc1
    buffer_load_dwordx4 a[76:79], v2, s[44:47], s71 offen offset:1024 sc1
    s_add_u32 s71, s82, s91
    buffer_load_dwordx4 a[80:83], v2, s[44:47], s71 offen offset:0 sc1
    buffer_load_dwordx4 a[84:87], v2, s[44:47], s71 offen offset:1024 sc1
    s_add_u32 s71, s82, s91
    s_add_u32 s71, s71, 88064
    buffer_load_dwordx4 a[88:91], v2, s[44:47], s71 offen offset:0 sc1
    buffer_load_dwordx4 a[92:95], v2, s[44:47], s71 offen offset:1024 sc1
    s_add_u32 s71, s82, s92
    buffer_load_dwordx4 v[128:131], v2, s[44:47], s71 offen offset:0 sc1
    buffer_load_dwordx4 v[132:135], v2, s[44:47], s71 offen offset:1024 sc1
    s_add_u32 s71, s82, s92
    s_add_u32 s71, s71, 88064
    buffer_load_dwordx4 v[136:139], v2, s[44:47], s71 offen offset:0 sc1
    buffer_load_dwordx4 v[140:143], v2, s[44:47], s71 offen offset:1024 sc1
    s_add_u32 m0, s89, 0
    s_lshl_b32 s70, s95, 4
    buffer_load_dwordx4 v28, s[32:35], s70 offen offset:0 lds
    buffer_load_dwordx4 v29, s[32:35], s70 offen offset:1024 lds
    buffer_load_dwordx4 v30, s[32:35], s70 offen offset:2048 lds
    buffer_load_dwordx4 v31, s[32:35], s70 offen offset:3072 lds
    s_add_u32 m0, s89, 16384
    s_lshl_b32 s70, s96, 4
    buffer_load_dwordx4 v28, s[32:35], s70 offen offset:0 lds
    buffer_load_dwordx4 v29, s[32:35], s70 offen offset:1024 lds
    buffer_load_dwordx4 v30, s[32:35], s70 offen offset:2048 lds
    buffer_load_dwordx4 v31, s[32:35], s70 offen offset:3072 lds
    v_and_b32 v19, 7, v1
    v_lshlrev_b32 v19, 4, v19
    s_lshl_b32 s75, s59, 9
    s_add_u32 s75, s75, 0xb02080
    s_cmp_lg_u32 s56, 0
    s_cbranch_scc1 L_po5
    buffer_load_dwordx4 v[20:23], v19, s[44:47], s75 offen sc1
    s_waitcnt vmcnt(0)
    s_mov_b32 s86, 0
L_pc6:
    v_xor_b32 v20, s61, v20
    v_xor_b32 v21, s61, v21
    v_xor_b32 v22, s61, v22
    v_xor_b32 v23, s61, v23
    v_or3_b32 v20, v20, v21, v22
    v_or_b32 v20, v20, v23
    v_cmp_eq_u32 vcc, 0, v20
    s_nop 1
    s_cmp_eq_u64 vcc, -1
    s_cbranch_scc1 L_pd6
    s_add_u32 s86, s86, 1
    s_cmp_ge_u32 s86, 200000
    s_cbranch_scc1 L_pd6
    s_sleep 4
    buffer_load_dwordx4 v[20:23], v19, s[44:47], s75 offen sc1
    s_waitcnt vmcnt(0)
    s_branch L_pc6
L_pd6:
    v_mov_b32 v13, 162368
    v_mov_b32 v14, 1
    ds_write_b32 v13, v14
    s_branch L_pe5
L_po5:
    v_mov_b32 v17, 162368
    s_mov_b32 s86, 0
L_lw7:
    ds_read_b32 v20, v17
    s_waitcnt lgkmcnt(0)
    v_cmp_eq_u32 vcc, 1, v20
    s_nop 1
    s_cmp_eq_u64 vcc, -1
    s_cbranch_scc1 L_ld7
    s_add_u32 s86, s86, 1
    s_cmp_ge_u32 s86, 1600000
    s_cbranch_scc1 L_ld7
    s_sleep 1
    s_branch L_lw7
L_ld7:
    s_waitcnt lgkmcnt(0)
L_pe5:
    s_waitcnt lgkmcnt(0)
    s_add_u32 s71, s82, s93
    buffer_load_dwordx4 v[48:51], v2, s[44:47], s71 offen offset:0 sc1
    buffer_load_dwordx4 v[52:55], v2, s[44:47], s71 offen offset:1024 sc1
    s_add_u32 s71, s82, s93
    s_add_u32 s71, s71, 88064
    buffer_load_dwordx4 v[56:59], v2, s[44:47], s71 offen offset:0 sc1
    buffer_load_dwordx4 v[60:63], v2, s[44:47], s71 offen offset:1024 sc1
    s_add_u32 s71, s82, s94
    buffer_load_dwordx4 v[144:147], v2, s[44:47], s71 offen offset:0 sc1
    buffer_load_dwordx4 v[148:151], v2, s[44:47], s71 offen offset:1024 sc1
    s_add_u32 s71, s82, s94
    s_add_u32 s71, s71, 88064
    buffer_load_dwordx4 v[152:155], v2, s[44:47], s71 offen offset:0 sc1
    buffer_load_dwordx4 v[156:159], v2, s[44:47], s71 offen offset:1024 sc1
    s_waitcnt vmcnt(27)
    v_mfma_f32_32x32x16_bf16 a[0:15], v[96:99], a[64:67], 0
    v_mfma_f32_32x32x16_bf16 a[32:47], v[100:103], a[64:67], 0
    s_waitcnt vmcnt(25)
    v_mfma_f32_32x32x16_bf16 a[16:31], v[96:99], a[72:75], 0
    v_mfma_f32_32x32x16_bf16 a[48:63], v[100:103], a[72:75], 0
    v_mfma_f32_32x32x16_bf16 a[0:15], v[104:107], a[68:71], a[0:15]
    v_mfma_f32_32x32x16_bf16 a[32:47], v[108:111], a[68:71], a[32:47]
    s_waitcnt vmcnt(24)
    v_mfma_f32_32x32x16_bf16 a[16:31], v[104:107], a[76:79], a[16:31]
    v_mfma_f32_32x32x16_bf16 a[48:63], v[108:111], a[76:79], a[48:63]
    s_add_u32 s71, s82, s95
    buffer_load_dwordx4 a[64:67], v2, s[44:47], s71 offen offset:0 sc1
    buffer_load_dwordx4 a[68:71], v2, s[44:47], s71 offen offset:1024 sc1
    s_add_u32 s71, s82, s95
    s_add_u32 s71, s71, 88064
    buffer_load_dwordx4 a[72:75], v2, s[44:47], s71 offen offset:0 sc1
    buffer_load_dwordx4 a[76:79], v2, s[44:47], s71 offen offset:1024 sc1
    s_waitcnt vmcnt(16)
    ds_read_b64_tr_b16 v[96:97], v10 offset:0
    ds_read_b64_tr_b16 v[98:99], v10 offset:1024
    ds_read_b64_tr_b16 v[100:101], v11 offset:0
    ds_read_b64_tr_b16 v[102:103], v11 offset:1024
    ds_read_b64_tr_b16 v[104:105], v10 offset:2048
    ds_read_b64_tr_b16 v[106:107], v10 offset:3072
    ds_read_b64_tr_b16 v[108:109], v11 offset:2048
    ds_read_b64_tr_b16 v[110:111], v11 offset:3072
    v_mfma_f32_32x32x16_bf16 a[0:15], v[112:115], a[80:83], a[0:15]
    v_mfma_f32_32x32x16_bf16 a[32:47], v[116:119], a[80:83], a[32:47]
    v_mfma_f32_32x32x16_bf16 a[16:31], v[112:115], a[88:91], a[16:31]
    v_mfma_f32_32x32x16_bf16 a[48:63], v[116:119], a[88:91], a[48:63]
    v_mfma_f32_32x32x16_bf16 a[0:15], v[120:123], a[84:87], a[0:15]
    v_mfma_f32_32x32x16_bf16 a[32:47], v[124:127], a[84:87], a[32:47]
    v_mfma_f32_32x32x16_bf16 a[16:31], v[120:123], a[92:95], a[16:31]
    v_mfma_f32_32x32x16_bf16 a[48:63], v[124:127], a[92:95], a[48:63]
    s_add_u32 s71, s82, s96
    buffer_load_dwordx4 a[80:83], v2, s[44:47], s71 offen offset:0 sc1
    buffer_load_dwordx4 a[84:87], v2, s[44:47], s71 offen offset:1024 sc1
    s_add_u32 s71, s82, s96
    s_add_u32 s71, s71, 88064
    buffer_load_dwordx4 a[88:91], v2, s[44:47], s71 offen offset:0 sc1
    buffer_load_dwordx4 a[92:95], v2, s[44:47], s71 offen offset:1024 sc1
    s_waitcnt vmcnt(16)
    ds_read_b64_tr_b16 v[112:113], v10 offset:16384
    ds_read_b64_tr_b16 v[114:115], v10 offset:17408
    ds_read_b64_tr_b16 v[116:117], v11 offset:16384
    ds_read_b64_tr_b16 v[118:119], v11 offset:17408
    ds_read_b64_tr_b16 v[120:121], v10 offset:18432
    ds_read_b64_tr_b16 v[122:123], v10 offset:19456
    ds_read_b64_tr_b16 v[124:125], v11 offset:18432
    ds_read_b64_tr_b16 v[126:127], v11 offset:19456
    v_mfma_f32_32x32x16_bf16 a[0:15], v[64:67], v[128:131], a[0:15]
    v_mfma_f32_32x32x16_bf16 a[32:47], v[68:71], v[128:131], a[32:47]
    v_mfma_f32_32x32x16_bf16 a[16:31], v[64:67], v[136:139], a[16:31]
    v_mfma_f32_32x32x16_bf16 a[48:63], v[68:71], v[136:139], a[48:63]
    v_mfma_f32_32x32x16_bf16 a[0:15], v[72:75], v[132:135], a[0:15]
    v_mfma_f32_32x32x16_bf16 a[32:47], v[76:79], v[132:135], a[32:47]
    v_mfma_f32_32x32x16_bf16 a[16:31], v[72:75], v[140:143], a[16:31]
    v_mfma_f32_32x32x16_bf16 a[48:63], v[76:79], v[140:143], a[48:63]
    s_waitcnt lgkmcnt(0)
    s_add_u32 s71, s56, 20
    s_lshl_b32 s62, s71, 2
    s_add_u32 s62, s62, 162304
    v_mov_b32 v13, s62
    v_mov_b32 v14, 1
    s_mov_b64 exec, 1
    ds_write_b32 v13, v14
    s_mov_b64 exec, -1
    s_waitcnt vmcnt(15)
    v_mfma_f32_32x32x16_bf16 a[0:15], v[80:83], v[48:51], a[0:15]
    v_mfma_f32_32x32x16_bf16 a[32:47], v[84:87], v[48:51], a[32:47]
    s_waitcnt vmcnt(13)
    v_mfma_f32_32x32x16_bf16 a[16:31], v[80:83], v[56:59], a[16:31]
    v_mfma_f32_32x32x16_bf16 a[48:63], v[84:87], v[56:59], a[48:63]
    v_mfma_f32_32x32x16_bf16 a[0:15], v[88:91], v[52:55], a[0:15]
    v_mfma_f32_32x32x16_bf16 a[32:47], v[92:95], v[52:55], a[32:47]
    s_waitcnt vmcnt(12)
    v_mfma_f32_32x32x16_bf16 a[16:31], v[88:91], v[60:63], a[16:31]
    v_mfma_f32_32x32x16_bf16 a[48:63], v[92:95], v[60:63], a[48:63]
    s_waitcnt vmcnt(11)
    v_mfma_f32_32x32x16_bf16 a[0:15], v[32:35], v[144:147], a[0:15]
    v_mfma_f32_32x32x16_bf16 a[32:47], v[36:39], v[144:147], a[32:47]
    s_waitcnt vmcnt(9)
    v_mfma_f32_32x32x16_bf16 a[16:31], v[32:35], v[152:155], a[16:31]
    v_mfma_f32_32x32x16_bf16 a[48:63], v[36:39], v[152:155], a[48:63]
    v_mfma_f32_32x32x16_bf16 a[0:15], v[40:43], v[148:151], a[0:15]
    v_mfma_f32_32x32x16_bf16 a[32:47], v[44:47], v[148:151], a[32:47]
    s_waitcnt vmcnt(8)
    v_mfma_f32_32x32x16_bf16 a[16:31], v[40:43], v[156:159], a[16:31]
    v_mfma_f32_32x32x16_bf16 a[48:63], v[44:47], v[156:159], a[48:63]
    s_waitcnt vmcnt(7)
    v_mfma_f32_32x32x16_bf16 a[0:15], v[96:99], a[64:67], a[0:15]
    v_mfma_f32_32x32x16_bf16 a[32:47], v[100:103], a[64:67], a[32:47]
    s_waitcnt vmcnt(5)
    v_mfma_f32_32x32x16_bf16 a[16:31], v[96:99], a[72:75], a[16:31]
    v_mfma_f32_32x32x16_bf16 a[48:63], v[100:103], a[72:75], a[48:63]
    v_mfma_f32_32x32x16_bf16 a[0:15], v[104:107], a[68:71], a[0:15]
    v_mfma_f32_32x32x16_bf16 a[32:47], v[108:111], a[68:71], a[32:47]
    s_waitcnt vmcnt(4)
    v_mfma_f32_32x32x16_bf16 a[16:31], v[104:107], a[76:79], a[16:31]
    v_mfma_f32_32x32x16_bf16 a[48:63], v[108:111], a[76:79], a[48:63]
    s_waitcnt vmcnt(3)
    v_mfma_f32_32x32x16_bf16 a[0:15], v[112:115], a[80:83], a[0:15]
    v_mfma_f32_32x32x16_bf16 a[32:47], v[116:119], a[80:83], a[32:47]
    s_waitcnt vmcnt(1)
    v_mfma_f32_32x32x16_bf16 a[16:31], v[112:115], a[88:91], a[16:31]
    v_mfma_f32_32x32x16_bf16 a[48:63], v[116:119], a[88:91], a[48:63]
    v_mfma_f32_32x32x16_bf16 a[0:15], v[120:123], a[84:87], a[0:15]
    v_mfma_f32_32x32x16_bf16 a[32:47], v[124:127], a[84:87], a[32:47]
    s_waitcnt vmcnt(0)
    v_mfma_f32_32x32x16_bf16 a[16:31], v[120:123], a[92:95], a[16:31]
    v_mfma_f32_32x32x16_bf16 a[48:63], v[124:127], a[92:95], a[48:63]
    v_lshrrev_b32 v13, 3, v0
    v_lshlrev_b32 v13, 2, v13
    s_lshl_b32 s62, s59, 8
    s_add_u32 s62, s62, 0xa00000
    buffer_load_dwordx4 v[28:31], v26, s[4:7], 0 offen
    v_mov_b32 v13, 162384
    s_mov_b32 s86, 0
L_lw8:
    ds_read_b128 v[20:23], v13
    s_waitcnt lgkmcnt(0)
    v_and_b32 v20, v20, v21
    v_and_b32 v22, v22, v23
    v_and_b32 v20, v20, v22
    v_cmp_eq_u32 vcc, 1, v20
    s_nop 1
    s_cmp_eq_u64 vcc, -1
    s_cbranch_scc1 L_ld8
    s_add_u32 s86, s86, 1
    s_cmp_ge_u32 s86, 1600000
    s_cbranch_scc1 L_ld8
    s_sleep 1
    s_branch L_lw8
L_ld8:
    s_waitcnt lgkmcnt(0)
    s_mul_i32 s71, s56, 17408
    v_and_b32 v13, 31, v1
    v_mul_u32_u24 v13, 272, v13
    v_lshrrev_b32 v14, 5, v1
    v_lshl_add_u32 v13, v14, 4, v13
    v_add_u32 v13, s71, v13
    s_nop 7
    ds_write_b128 v13, a[0:3] offset:0
    ds_write_b128 v13, a[4:7] offset:32
    ds_write_b128 v13, a[8:11] offset:64
    ds_write_b128 v13, a[12:15] offset:96
    ds_write_b128 v13, a[16:19] offset:8704
    ds_write_b128 v13, a[20:23] offset:8736
    ds_write_b128 v13, a[24:27] offset:8768
    ds_write_b128 v13, a[28:31] offset:8800
    ds_write_b128 v13, a[32:35] offset:128
    ds_write_b128 v13, a[36:39] offset:160
    ds_write_b128 v13, a[40:43] offset:192
    ds_write_b128 v13, a[44:47] offset:224
    ds_write_b128 v13, a[48:51] offset:8832
    ds_write_b128 v13, a[52:55] offset:8864
    ds_write_b128 v13, a[56:59] offset:8896
    ds_write_b128 v13, a[60:63] offset:8928
    v_mov_b32 v13, 162416
    s_mov_b32 s86, 0
L_lw9:
    ds_read_b128 v[20:23], v13
    s_waitcnt lgkmcnt(0)
    v_and_b32 v20, v20, v21
    v_and_b32 v22, v22, v23
    v_and_b32 v20, v20, v22
    v_cmp_eq_u32 vcc, 1, v20
    s_nop 1
    s_cmp_eq_u64 vcc, -1
    s_cbranch_scc1 L_ld9
    s_add_u32 s86, s86, 1
    s_cmp_ge_u32 s86, 1600000
    s_cbranch_scc1 L_ld9
    s_sleep 1
    s_branch L_lw9
L_ld9:
    s_waitcnt lgkmcnt(0)
    s_lshl_b32 s75, s60, 9
    s_add_u32 s75, s75, 0xb08000
    v_add_u32 v19, s75, v2
    s_lshr_b32 s75, s59, 1
    s_lshl_b32 s75, s75, 4
    s_add_u32 s75, s75, 0xb0a000
    v_mov_b32 v13, s75
    v_cmp_gt_u32 vcc, 32, v1
    s_mov_b32 s75, 0
    s_nop 0
    v_cndmask_b32 v19, v13, v19, vcc
    v_lshrrev_b32 v14, 3, v0
    v_and_b32 v16, 7, v0
    v_lshlrev_b32 v13, 4, v16
    v_lshl_add_u32 v104, v14, 12, v13
    v_lshrrev_b32 v15, 6, v0
    v_xor_b32 v15, v15, v16
    v_lshlrev_b32 v15, 4, v15
    v_lshl_add_u32 v15, v14, 7, v15
    v_xor_b32 v106, 64, v15
    v_add_u32 v105, 152064, v15
    v_add_u32 v106, 152064, v106
    s_lshl_b32 s64, s60, 18
    s_lshl_b32 s65, s59, 7
    s_add_u32 s64, s64, s65
    s_add_u32 s64, s64, 0x800000
    s_add_u32 s65, s64, 0x20000
    s_cmp_lg_u32 s56, 0
    s_cbranch_scc1 L_po10
    buffer_load_dwordx4 v[20:23], v19, s[44:47], s75 offen sc1
    s_waitcnt vmcnt(0)
    s_mov_b32 s86, 0
L_pc11:
    v_xor_b32 v20, s61, v20
    v_xor_b32 v21, s61, v21
    v_xor_b32 v22, s61, v22
    v_xor_b32 v23, s61, v23
    v_or3_b32 v20, v20, v21, v22
    v_or_b32 v20, v20, v23
    v_cmp_eq_u32 vcc, 0, v20
    s_nop 1
    s_cmp_eq_u64 vcc, -1
    s_cbranch_scc1 L_pd11
    s_add_u32 s86, s86, 1
    s_cmp_ge_u32 s86, 200000
    s_cbranch_scc1 L_pd11
    s_sleep 4
    buffer_load_dwordx4 v[20:23], v19, s[44:47], s75 offen sc1
    s_waitcnt vmcnt(0)
    s_branch L_pc11
L_pd11:
    v_mov_b32 v13, 162364
    v_mov_b32 v14, 1
    ds_write_b32 v13, v14
    s_branch L_pe10
L_po10:
    v_mov_b32 v17, 162364
    s_mov_b32 s86, 0
L_lw12:
    ds_read_b32 v20, v17
    s_waitcnt lgkmcnt(0)
    v_cmp_eq_u32 vcc, 1, v20
    s_nop 1
    s_cmp_eq_u64 vcc, -1
    s_cbranch_scc1 L_ld12
    s_add_u32 s86, s86, 1
    s_cmp_ge_u32 s86, 1600000
    s_cbranch_scc1 L_ld12
    s_sleep 1
    s_branch L_lw12
L_ld12:
    s_waitcnt lgkmcnt(0)
L_pe10:
    s_waitcnt lgkmcnt(0)
    buffer_load_dwordx4 v[96:99], v104, s[44:47], s64 offen sc1
    buffer_load_dwordx4 v[100:103], v104, s[44:47], s65 offen sc1
    v_lshlrev_b32 v13, 2, v1
    s_lshl_b32 s64, s59, 8
    s_add_u32 s64, s64, 0xa00000
    buffer_load_dword v107, v13, s[44:47], s64 offen sc1
    v_add_u32 v13, 162816, v13
    s_waitcnt vmcnt(0)
    ds_write_b32 v13, v107
    ds_write_b128 v105, v[96:99]
    ds_write_b128 v106, v[100:103] offset:4096
    v_lshrrev_b32 v14, 3, v0
    v_and_b32 v16, 7, v0
    v_mul_u32_u24 v13, 272, v14
    v_lshl_add_u32 v13, v16, 5, v13
    v_add_u32 v17, 82432, v13
    v_lshrrev_b32 v15, 6, v0
    v_xor_b32 v15, v15, v16
    v_lshlrev_b32 v15, 4, v15
    v_lshl_add_u32 v15, v16, 10, v15
    v_lshlrev_b32 v18, 2, v14
    v_add_u32 v18, 162816, v18
    v_and_b32 v14, 7, v14
    v_lshl_add_u32 v15, v14, 1, v15
    v_add_u32 v15, 152064, v15
    s_waitcnt lgkmcnt(0)
    v_mov_b32 v96, 0
    v_mov_b32 v97, 0
    v_mov_b32 v98, 0
    v_mov_b32 v99, 0
    v_mov_b32 v100, 0
    v_mov_b32 v101, 0
    v_mov_b32 v102, 0
    v_mov_b32 v103, 0
    s_barrier
    ds_read_b32 v12, v18
    ds_read_b128 v[32:35], v13 offset:0
    ds_read_b128 v[36:39], v13 offset:16
    ds_read_b128 v[40:43], v13 offset:17408
    ds_read_b128 v[44:47], v13 offset:17424
    ds_read_b128 v[48:51], v13 offset:34816
    ds_read_b128 v[52:55], v13 offset:34832
    ds_read_b128 v[56:59], v13 offset:52224
    ds_read_b128 v[60:63], v13 offset:52240
    ds_read_b128 v[64:67], v17 offset:0
    ds_read_b128 v[68:71], v17 offset:16
    ds_read_b128 v[72:75], v17 offset:17408
    ds_read_b128 v[76:79], v17 offset:17424
    ds_read_b128 v[80:83], v17 offset:34816
    ds_read_b128 v[84:87], v17 offset:34832
    ds_read_b128 v[88:91], v17 offset:52224
    ds_read_b128 v[92:95], v17 offset:52240
    ds_read_u16_d16_hi v96, v15 offset:0
    ds_read_u16_d16_hi v97, v15 offset:128
    ds_read_u16_d16_hi v98, v15 offset:256
    ds_read_u16_d16_hi v99, v15 offset:384
    ds_read_u16_d16_hi v100, v15 offset:512
    ds_read_u16_d16_hi v101, v15 offset:640
    ds_read_u16_d16_hi v102, v15 offset:768
    ds_read_u16_d16_hi v103, v15 offset:896
    s_waitcnt lgkmcnt(15)
    v_lshlrev_b32 v104, 16, v12
    v_and_b32 v105, s77, v12
    v_lshlrev_b32 v112, 16, v28
    v_and_b32 v113, s77, v28
    v_lshlrev_b32 v114, 16, v29
    v_and_b32 v115, s77, v29
    v_lshlrev_b32 v116, 16, v30
    v_and_b32 v117, s77, v30
    v_lshlrev_b32 v118, 16, v31
    v_and_b32 v119, s77, v31
    v_add_f32 v32, v32, v40
    v_add_f32 v33, v33, v41
    v_add_f32 v34, v34, v42
    v_add_f32 v35, v35, v43
    v_add_f32 v36, v36, v44
    v_add_f32 v37, v37, v45
    v_add_f32 v38, v38, v46
    v_add_f32 v39, v39, v47
    v_add_f32 v48, v48, v56
    v_add_f32 v49, v49, v57
    v_add_f32 v50, v50, v58
    v_add_f32 v51, v51, v59
    v_add_f32 v52, v52, v60
    v_add_f32 v53, v53, v61
    v_add_f32 v54, v54, v62
    v_add_f32 v55, v55, v63
    s_waitcnt lgkmcnt(12)
    v_add_f32 v64, v64, v72
    v_add_f32 v65, v65, v73
    v_add_f32 v66, v66, v74
    v_add_f32 v67, v67, v75
    v_add_f32 v68, v68, v76
    v_add_f32 v69, v69, v77
    v_add_f32 v70, v70, v78
    v_add_f32 v71, v71, v79
    s_waitcnt lgkmcnt(8)
    v_add_f32 v80, v80, v88
    v_add_f32 v81, v81, v89
    v_add_f32 v82, v82, v90
    v_add_f32 v83, v83, v91
    v_add_f32 v84, v84, v92
    v_add_f32 v85, v85, v93
    v_add_f32 v86, v86, v94
    v_add_f32 v87, v87, v95
    v_add_f32 v32, v32, v48
    v_add_f32 v64, v64, v80
    v_add_f32 v33, v33, v49
    v_add_f32 v65, v65, v81
    v_add_f32 v34, v34, v50
    v_add_f32 v66, v66, v82
    v_add_f32 v35, v35, v51
    v_add_f32 v67, v67, v83
    v_add_f32 v36, v36, v52
    v_add_f32 v68, v68, v84
    v_add_f32 v37, v37, v53
    v_add_f32 v69, v69, v85
    v_add_f32 v38, v38, v54
    v_add_f32 v70, v70, v86
    v_add_f32 v39, v39, v55
    v_add_f32 v71, v71, v87
    v_add_f32 v32, v32, v64
    v_add_f32 v33, v33, v65
    v_add_f32 v34, v34, v66
    v_add_f32 v35, v35, v67
    v_add_f32 v36, v36, v68
    v_add_f32 v37, v37, v69
    v_add_f32 v38, v38, v70
    v_add_f32 v39, v39, v71
    s_waitcnt lgkmcnt(0)
    v_cvt_pk_bf16_f32 v106, v32, v33
    v_lshlrev_b32 v32, 16, v106
    v_and_b32 v33, s77, v106
    v_mul_f32 v112, v112, v96
    v_mul_f32 v113, v113, v97
    v_mul_f32 v32, v32, v105
    v_mul_f32 v33, v33, v105
    v_cvt_pk_bf16_f32 v107, v112, v113
    v_lshlrev_b32 v112, 16, v107
    v_and_b32 v113, s77, v107
    v_mul_f32 v112, v112, v104
    v_mul_f32 v113, v113, v104
    v_cvt_pk_bf16_f32 v106, v32, v33
    v_lshlrev_b32 v32, 16, v106
    v_and_b32 v33, s77, v106
    v_cvt_pk_bf16_f32 v107, v112, v113
    v_lshlrev_b32 v112, 16, v107
    v_and_b32 v113, s77, v107
    v_add_f32 v32, v32, v112
    v_add_f32 v33, v33, v113
    v_cvt_pk_bf16_f32 v48, v32, v33
    v_cvt_pk_bf16_f32 v108, v34, v35
    v_lshlrev_b32 v34, 16, v108
    v_and_b32 v35, s77, v108
    v_mul_f32 v114, v114, v98
    v_mul_f32 v115, v115, v99
    v_mul_f32 v34, v34, v105
    v_mul_f32 v35, v35, v105
    v_cvt_pk_bf16_f32 v109, v114, v115
    v_lshlrev_b32 v114, 16, v109
    v_and_b32 v115, s77, v109
    v_mul_f32 v114, v114, v104
    v_mul_f32 v115, v115, v104
    v_cvt_pk_bf16_f32 v108, v34, v35
    v_lshlrev_b32 v34, 16, v108
    v_and_b32 v35, s77, v108
    v_cvt_pk_bf16_f32 v109, v114, v115
    v_lshlrev_b32 v114, 16, v109
    v_and_b32 v115, s77, v109
    v_add_f32 v34, v34, v114
    v_add_f32 v35, v35, v115
    v_cvt_pk_bf16_f32 v49, v34, v35
    v_cvt_pk_bf16_f32 v106, v36, v37
    v_lshlrev_b32 v36, 16, v106
    v_and_b32 v37, s77, v106
    v_mul_f32 v116, v116, v100
    v_mul_f32 v117, v117, v101
    v_mul_f32 v36, v36, v105
    v_mul_f32 v37, v37, v105
    v_cvt_pk_bf16_f32 v107, v116, v117
    v_lshlrev_b32 v116, 16, v107
    v_and_b32 v117, s77, v107
    v_mul_f32 v116, v116, v104
    v_mul_f32 v117, v117, v104
    v_cvt_pk_bf16_f32 v106, v36, v37
    v_lshlrev_b32 v36, 16, v106
    v_and_b32 v37, s77, v106
    v_cvt_pk_bf16_f32 v107, v116, v117
    v_lshlrev_b32 v116, 16, v107
    v_and_b32 v117, s77, v107
    v_add_f32 v36, v36, v116
    v_add_f32 v37, v37, v117
    v_cvt_pk_bf16_f32 v50, v36, v37
    v_cvt_pk_bf16_f32 v108, v38, v39
    v_lshlrev_b32 v38, 16, v108
    v_and_b32 v39, s77, v108
    v_mul_f32 v118, v118, v102
    v_mul_f32 v119, v119, v103
    v_mul_f32 v38, v38, v105
    v_mul_f32 v39, v39, v105
    v_cvt_pk_bf16_f32 v109, v118, v119
    v_lshlrev_b32 v118, 16, v109
    v_and_b32 v119, s77, v109
    v_mul_f32 v118, v118, v104
    v_mul_f32 v119, v119, v104
    v_cvt_pk_bf16_f32 v108, v38, v39
    v_lshlrev_b32 v38, 16, v108
    v_and_b32 v39, s77, v108
    v_cvt_pk_bf16_f32 v109, v118, v119
    v_lshlrev_b32 v118, 16, v109
    v_and_b32 v119, s77, v109
    v_add_f32 v38, v38, v118
    v_add_f32 v39, v39, v119
    v_cvt_pk_bf16_f32 v51, v38, v39
    buffer_store_dwordx4 v[48:51], v26, s[40:43], 0 offen
    s_branch L_fin
L_c_g:
    s_waitcnt vmcnt(0) lgkmcnt(0)
    ds_read_b128 v[136:139], v157 offset:0
    v_accvgpr_read_b32 v128, a56
    v_accvgpr_read_b32 v129, a60
    v_accvgpr_read_b32 v130, a64
    v_accvgpr_read_b32 v131, a68
    v_accvgpr_read_b32 v132, a72
    v_accvgpr_read_b32 v133, a76
    v_accvgpr_read_b32 v134, a80
    s_waitcnt lgkmcnt(0)
    v_lshlrev_b32 v140, 16, v128
    v_lshlrev_b32 v141, 16, v129
    v_lshlrev_b32 v142, 16, v130
    v_lshlrev_b32 v143, 16, v131
    v_lshlrev_b32 v144, 16, v132
    v_lshlrev_b32 v145, 16, v133
    v_lshlrev_b32 v146, 16, v134
    v_lshlrev_b32 v147, 16, v136
    v_and_b32 v148, s77, v136
    v_lshlrev_b32 v149, 16, v137
    v_and_b32 v150, s77, v137
    v_mul_f32 v153, v140, v150
    v_mul_f32 v154, v141, v150
    v_cvt_pk_bf16_f32 v155, v153, v154
    v_lshlrev_b32 v153, 16, v155
    v_and_b32 v154, s77, v155
    v_mul_f32 v151, v141, v149
    v_mul_f32 v152, v142, v149
    v_cvt_pk_bf16_f32 v155, v151, v152
    v_lshlrev_b32 v151, 16, v155
    v_and_b32 v152, s77, v155
    v_add_f32 v153, v153, v151
    v_add_f32 v154, v154, v152
    v_cvt_pk_bf16_f32 v155, v153, v154
    v_lshlrev_b32 v153, 16, v155
    v_and_b32 v154, s77, v155
    v_mul_f32 v151, v142, v148
    v_mul_f32 v152, v143, v148
    v_cvt_pk_bf16_f32 v155, v151, v152
    v_lshlrev_b32 v151, 16, v155
    v_and_b32 v152, s77, v155
    v_add_f32 v153, v153, v151
    v_add_f32 v154, v154, v152
    v_cvt_pk_bf16_f32 v155, v153, v154
    v_lshlrev_b32 v153, 16, v155
    v_and_b32 v154, s77, v155
    v_mul_f32 v151, v143, v147
    v_mul_f32 v152, v144, v147
    v_cvt_pk_bf16_f32 v155, v151, v152
    v_lshlrev_b32 v151, 16, v155
    v_and_b32 v152, s77, v155
    v_add_f32 v153, v153, v151
    v_add_f32 v154, v154, v152
    v_cvt_pk_bf16_f32 v155, v153, v154
    v_lshlrev_b32 v153, 16, v155
    v_and_b32 v154, s77, v155
    v_mul_f32 v153, v153, v145
    v_mul_f32 v154, v154, v146
    v_cvt_pk_bf16_f32 v151, v154, v153
    ds_write_b32 v156, v151 offset:0
    v_and_b32 v140, s77, v128
    v_and_b32 v141, s77, v129
    v_and_b32 v142, s77, v130
    v_and_b32 v143, s77, v131
    v_and_b32 v144, s77, v132
    v_and_b32 v145, s77, v133
    v_and_b32 v146, s77, v134
    v_lshlrev_b32 v147, 16, v138
    v_and_b32 v148, s77, v138
    v_lshlrev_b32 v149, 16, v139
    v_and_b32 v150, s77, v139
    v_mul_f32 v153, v140, v150
    v_mul_f32 v154, v141, v150
    v_cvt_pk_bf16_f32 v155, v153, v154
    v_lshlrev_b32 v153, 16, v155
    v_and_b32 v154, s77, v155
    v_mul_f32 v151, v141, v149
    v_mul_f32 v152, v142, v149
    v_cvt_pk_bf16_f32 v155, v151, v152
    v_lshlrev_b32 v151, 16, v155
    v_and_b32 v152, s77, v155
    v_add_f32 v153, v153, v151
    v_add_f32 v154, v154, v152
    v_cvt_pk_bf16_f32 v155, v153, v154
    v_lshlrev_b32 v153, 16, v155
    v_and_b32 v154, s77, v155
    v_mul_f32 v151, v142, v148
    v_mul_f32 v152, v143, v148
    v_cvt_pk_bf16_f32 v155, v151, v152
    v_lshlrev_b32 v151, 16, v155
    v_and_b32 v152, s77, v155
    v_add_f32 v153, v153, v151
    v_add_f32 v154, v154, v152
    v_cvt_pk_bf16_f32 v155, v153, v154
    v_lshlrev_b32 v153, 16, v155
    v_and_b32 v154, s77, v155
    v_mul_f32 v151, v143, v147
    v_mul_f32 v152, v144, v147
    v_cvt_pk_bf16_f32 v155, v151, v152
    v_lshlrev_b32 v151, 16, v155
    v_and_b32 v152, s77, v155
    v_add_f32 v153, v153, v151
    v_add_f32 v154, v154, v152
    v_cvt_pk_bf16_f32 v155, v153, v154
    v_lshlrev_b32 v153, 16, v155
    v_and_b32 v154, s77, v155
    v_mul_f32 v153, v153, v145
    v_mul_f32 v154, v154, v146
    v_cvt_pk_bf16_f32 v151, v154, v153
    ds_write_b32 v156, v151 offset:128
    ds_read_b128 v[136:139], v157 offset:16
    v_accvgpr_read_b32 v128, a57
    v_accvgpr_read_b32 v129, a61
    v_accvgpr_read_b32 v130, a65
    v_accvgpr_read_b32 v131, a69
    v_accvgpr_read_b32 v132, a73
    v_accvgpr_read_b32 v133, a77
    v_accvgpr_read_b32 v134, a81
    s_waitcnt lgkmcnt(0)
    v_lshlrev_b32 v140, 16, v128
    v_lshlrev_b32 v141, 16, v129
    v_lshlrev_b32 v142, 16, v130
    v_lshlrev_b32 v143, 16, v131
    v_lshlrev_b32 v144, 16, v132
    v_lshlrev_b32 v145, 16, v133
    v_lshlrev_b32 v146, 16, v134
    v_lshlrev_b32 v147, 16, v136
    v_and_b32 v148, s77, v136
    v_lshlrev_b32 v149, 16, v137
    v_and_b32 v150, s77, v137
    v_mul_f32 v153, v140, v150
    v_mul_f32 v154, v141, v150
    v_cvt_pk_bf16_f32 v155, v153, v154
    v_lshlrev_b32 v153, 16, v155
    v_and_b32 v154, s77, v155
    v_mul_f32 v151, v141, v149
    v_mul_f32 v152, v142, v149
    v_cvt_pk_bf16_f32 v155, v151, v152
    v_lshlrev_b32 v151, 16, v155
    v_and_b32 v152, s77, v155
    v_add_f32 v153, v153, v151
    v_add_f32 v154, v154, v152
    v_cvt_pk_bf16_f32 v155, v153, v154
    v_lshlrev_b32 v153, 16, v155
    v_and_b32 v154, s77, v155
    v_mul_f32 v151, v142, v148
    v_mul_f32 v152, v143, v148
    v_cvt_pk_bf16_f32 v155, v151, v152
    v_lshlrev_b32 v151, 16, v155
    v_and_b32 v152, s77, v155
    v_add_f32 v153, v153, v151
    v_add_f32 v154, v154, v152
    v_cvt_pk_bf16_f32 v155, v153, v154
    v_lshlrev_b32 v153, 16, v155
    v_and_b32 v154, s77, v155
    v_mul_f32 v151, v143, v147
    v_mul_f32 v152, v144, v147
    v_cvt_pk_bf16_f32 v155, v151, v152
    v_lshlrev_b32 v151, 16, v155
    v_and_b32 v152, s77, v155
    v_add_f32 v153, v153, v151
    v_add_f32 v154, v154, v152
    v_cvt_pk_bf16_f32 v155, v153, v154
    v_lshlrev_b32 v153, 16, v155
    v_and_b32 v154, s77, v155
    v_mul_f32 v153, v153, v145
    v_mul_f32 v154, v154, v146
    v_cvt_pk_bf16_f32 v151, v154, v153
    ds_write_b32 v156, v151 offset:256
    v_and_b32 v140, s77, v128
    v_and_b32 v141, s77, v129
    v_and_b32 v142, s77, v130
    v_and_b32 v143, s77, v131
    v_and_b32 v144, s77, v132
    v_and_b32 v145, s77, v133
    v_and_b32 v146, s77, v134
    v_lshlrev_b32 v147, 16, v138
    v_and_b32 v148, s77, v138
    v_lshlrev_b32 v149, 16, v139
    v_and_b32 v150, s77, v139
    v_mul_f32 v153, v140, v150
    v_mul_f32 v154, v141, v150
    v_cvt_pk_bf16_f32 v155, v153, v154
    v_lshlrev_b32 v153, 16, v155
    v_and_b32 v154, s77, v155
    v_mul_f32 v151, v141, v149
    v_mul_f32 v152, v142, v149
    v_cvt_pk_bf16_f32 v155, v151, v152
    v_lshlrev_b32 v151, 16, v155
    v_and_b32 v152, s77, v155
    v_add_f32 v153, v153, v151
    v_add_f32 v154, v154, v152
    v_cvt_pk_bf16_f32 v155, v153, v154
    v_lshlrev_b32 v153, 16, v155
    v_and_b32 v154, s77, v155
    v_mul_f32 v151, v142, v148
    v_mul_f32 v152, v143, v148
    v_cvt_pk_bf16_f32 v155, v151, v152
    v_lshlrev_b32 v151, 16, v155
    v_and_b32 v152, s77, v155
    v_add_f32 v153, v153, v151
    v_add_f32 v154, v154, v152
    v_cvt_pk_bf16_f32 v155, v153, v154
    v_lshlrev_b32 v153, 16, v155
    v_and_b32 v154, s77, v155
    v_mul_f32 v151, v143, v147
    v_mul_f32 v152, v144, v147
    v_cvt_pk_bf16_f32 v155, v151, v152
    v_lshlrev_b32 v151, 16, v155
    v_and_b32 v152, s77, v155
    v_add_f32 v153, v153, v151
    v_add_f32 v154, v154, v152
    v_cvt_pk_bf16_f32 v155, v153, v154
    v_lshlrev_b32 v153, 16, v155
    v_and_b32 v154, s77, v155
    v_mul_f32 v153, v153, v145
    v_mul_f32 v154, v154, v146
    v_cvt_pk_bf16_f32 v151, v154, v153
    ds_write_b32 v156, v151 offset:384
    ds_read_b128 v[136:139], v157 offset:32
    v_accvgpr_read_b32 v128, a58
    v_accvgpr_read_b32 v129, a62
    v_accvgpr_read_b32 v130, a66
    v_accvgpr_read_b32 v131, a70
    v_accvgpr_read_b32 v132, a74
    v_accvgpr_read_b32 v133, a78
    v_accvgpr_read_b32 v134, a82
    s_waitcnt lgkmcnt(0)
    v_lshlrev_b32 v140, 16, v128
    v_lshlrev_b32 v141, 16, v129
    v_lshlrev_b32 v142, 16, v130
    v_lshlrev_b32 v143, 16, v131
    v_lshlrev_b32 v144, 16, v132
    v_lshlrev_b32 v145, 16, v133
    v_lshlrev_b32 v146, 16, v134
    v_lshlrev_b32 v147, 16, v136
    v_and_b32 v148, s77, v136
    v_lshlrev_b32 v149, 16, v137
    v_and_b32 v150, s77, v137
    v_mul_f32 v153, v140, v150
    v_mul_f32 v154, v141, v150
    v_cvt_pk_bf16_f32 v155, v153, v154
    v_lshlrev_b32 v153, 16, v155
    v_and_b32 v154, s77, v155
    v_mul_f32 v151, v141, v149
    v_mul_f32 v152, v142, v149
    v_cvt_pk_bf16_f32 v155, v151, v152
    v_lshlrev_b32 v151, 16, v155
    v_and_b32 v152, s77, v155
    v_add_f32 v153, v153, v151
    v_add_f32 v154, v154, v152
    v_cvt_pk_bf16_f32 v155, v153, v154
    v_lshlrev_b32 v153, 16, v155
    v_and_b32 v154, s77, v155
    v_mul_f32 v151, v142, v148
    v_mul_f32 v152, v143, v148
    v_cvt_pk_bf16_f32 v155, v151, v152
    v_lshlrev_b32 v151, 16, v155
    v_and_b32 v152, s77, v155
    v_add_f32 v153, v153, v151
    v_add_f32 v154, v154, v152
    v_cvt_pk_bf16_f32 v155, v153, v154
    v_lshlrev_b32 v153, 16, v155
    v_and_b32 v154, s77, v155
    v_mul_f32 v151, v143, v147
    v_mul_f32 v152, v144, v147
    v_cvt_pk_bf16_f32 v155, v151, v152
    v_lshlrev_b32 v151, 16, v155
    v_and_b32 v152, s77, v155
    v_add_f32 v153, v153, v151
    v_add_f32 v154, v154, v152
    v_cvt_pk_bf16_f32 v155, v153, v154
    v_lshlrev_b32 v153, 16, v155
    v_and_b32 v154, s77, v155
    v_mul_f32 v153, v153, v145
    v_mul_f32 v154, v154, v146
    v_cvt_pk_bf16_f32 v151, v154, v153
    ds_write_b32 v156, v151 offset:512
    v_and_b32 v140, s77, v128
    v_and_b32 v141, s77, v129
    v_and_b32 v142, s77, v130
    v_and_b32 v143, s77, v131
    v_and_b32 v144, s77, v132
    v_and_b32 v145, s77, v133
    v_and_b32 v146, s77, v134
    v_lshlrev_b32 v147, 16, v138
    v_and_b32 v148, s77, v138
    v_lshlrev_b32 v149, 16, v139
    v_and_b32 v150, s77, v139
    v_mul_f32 v153, v140, v150
    v_mul_f32 v154, v141, v150
    v_cvt_pk_bf16_f32 v155, v153, v154
    v_lshlrev_b32 v153, 16, v155
    v_and_b32 v154, s77, v155
    v_mul_f32 v151, v141, v149
    v_mul_f32 v152, v142, v149
    v_cvt_pk_bf16_f32 v155, v151, v152
    v_lshlrev_b32 v151, 16, v155
    v_and_b32 v152, s77, v155
    v_add_f32 v153, v153, v151
    v_add_f32 v154, v154, v152
    v_cvt_pk_bf16_f32 v155, v153, v154
    v_lshlrev_b32 v153, 16, v155
    v_and_b32 v154, s77, v155
    v_mul_f32 v151, v142, v148
    v_mul_f32 v152, v143, v148
    v_cvt_pk_bf16_f32 v155, v151, v152
    v_lshlrev_b32 v151, 16, v155
    v_and_b32 v152, s77, v155
    v_add_f32 v153, v153, v151
    v_add_f32 v154, v154, v152
    v_cvt_pk_bf16_f32 v155, v153, v154
    v_lshlrev_b32 v153, 16, v155
    v_and_b32 v154, s77, v155
    v_mul_f32 v151, v143, v147
    v_mul_f32 v152, v144, v147
    v_cvt_pk_bf16_f32 v155, v151, v152
    v_lshlrev_b32 v151, 16, v155
    v_and_b32 v152, s77, v155
    v_add_f32 v153, v153, v151
    v_add_f32 v154, v154, v152
    v_cvt_pk_bf16_f32 v155, v153, v154
    v_lshlrev_b32 v153, 16, v155
    v_and_b32 v154, s77, v155
    v_mul_f32 v153, v153, v145
    v_mul_f32 v154, v154, v146
    v_cvt_pk_bf16_f32 v151, v154, v153
    ds_write_b32 v156, v151 offset:640
    ds_read_b128 v[136:139], v157 offset:48
    v_accvgpr_read_b32 v128, a59
    v_accvgpr_read_b32 v129, a63
    v_accvgpr_read_b32 v130, a67
    v_accvgpr_read_b32 v131, a71
    v_accvgpr_read_b32 v132, a75
    v_accvgpr_read_b32 v133, a79
    v_accvgpr_read_b32 v134, a83
    s_waitcnt lgkmcnt(0)
    v_lshlrev_b32 v140, 16, v128
    v_lshlrev_b32 v141, 16, v129
    v_lshlrev_b32 v142, 16, v130
    v_lshlrev_b32 v143, 16, v131
    v_lshlrev_b32 v144, 16, v132
    v_lshlrev_b32 v145, 16, v133
    v_lshlrev_b32 v146, 16, v134
    v_lshlrev_b32 v147, 16, v136
    v_and_b32 v148, s77, v136
    v_lshlrev_b32 v149, 16, v137
    v_and_b32 v150, s77, v137
    v_mul_f32 v153, v140, v150
    v_mul_f32 v154, v141, v150
    v_cvt_pk_bf16_f32 v155, v153, v154
    v_lshlrev_b32 v153, 16, v155
    v_and_b32 v154, s77, v155
    v_mul_f32 v151, v141, v149
    v_mul_f32 v152, v142, v149
    v_cvt_pk_bf16_f32 v155, v151, v152
    v_lshlrev_b32 v151, 16, v155
    v_and_b32 v152, s77, v155
    v_add_f32 v153, v153, v151
    v_add_f32 v154, v154, v152
    v_cvt_pk_bf16_f32 v155, v153, v154
    v_lshlrev_b32 v153, 16, v155
    v_and_b32 v154, s77, v155
    v_mul_f32 v151, v142, v148
    v_mul_f32 v152, v143, v148
    v_cvt_pk_bf16_f32 v155, v151, v152
    v_lshlrev_b32 v151, 16, v155
    v_and_b32 v152, s77, v155
    v_add_f32 v153, v153, v151
    v_add_f32 v154, v154, v152
    v_cvt_pk_bf16_f32 v155, v153, v154
    v_lshlrev_b32 v153, 16, v155
    v_and_b32 v154, s77, v155
    v_mul_f32 v151, v143, v147
    v_mul_f32 v152, v144, v147
    v_cvt_pk_bf16_f32 v155, v151, v152
    v_lshlrev_b32 v151, 16, v155
    v_and_b32 v152, s77, v155
    v_add_f32 v153, v153, v151
    v_add_f32 v154, v154, v152
    v_cvt_pk_bf16_f32 v155, v153, v154
    v_lshlrev_b32 v153, 16, v155
    v_and_b32 v154, s77, v155
    v_mul_f32 v153, v153, v145
    v_mul_f32 v154, v154, v146
    v_cvt_pk_bf16_f32 v151, v154, v153
    ds_write_b32 v156, v151 offset:768
    v_and_b32 v140, s77, v128
    v_and_b32 v141, s77, v129
    v_and_b32 v142, s77, v130
    v_and_b32 v143, s77, v131
    v_and_b32 v144, s77, v132
    v_and_b32 v145, s77, v133
    v_and_b32 v146, s77, v134
    v_lshlrev_b32 v147, 16, v138
    v_and_b32 v148, s77, v138
    v_lshlrev_b32 v149, 16, v139
    v_and_b32 v150, s77, v139
    v_mul_f32 v153, v140, v150
    v_mul_f32 v154, v141, v150
    v_cvt_pk_bf16_f32 v155, v153, v154
    v_lshlrev_b32 v153, 16, v155
    v_and_b32 v154, s77, v155
    v_mul_f32 v151, v141, v149
    v_mul_f32 v152, v142, v149
    v_cvt_pk_bf16_f32 v155, v151, v152
    v_lshlrev_b32 v151, 16, v155
    v_and_b32 v152, s77, v155
    v_add_f32 v153, v153, v151
    v_add_f32 v154, v154, v152
    v_cvt_pk_bf16_f32 v155, v153, v154
    v_lshlrev_b32 v153, 16, v155
    v_and_b32 v154, s77, v155
    v_mul_f32 v151, v142, v148
    v_mul_f32 v152, v143, v148
    v_cvt_pk_bf16_f32 v155, v151, v152
    v_lshlrev_b32 v151, 16, v155
    v_and_b32 v152, s77, v155
    v_add_f32 v153, v153, v151
    v_add_f32 v154, v154, v152
    v_cvt_pk_bf16_f32 v155, v153, v154
    v_lshlrev_b32 v153, 16, v155
    v_and_b32 v154, s77, v155
    v_mul_f32 v151, v143, v147
    v_mul_f32 v152, v144, v147
    v_cvt_pk_bf16_f32 v155, v151, v152
    v_lshlrev_b32 v151, 16, v155
    v_and_b32 v152, s77, v155
    v_add_f32 v153, v153, v151
    v_add_f32 v154, v154, v152
    v_cvt_pk_bf16_f32 v155, v153, v154
    v_lshlrev_b32 v153, 16, v155
    v_and_b32 v154, s77, v155
    v_mul_f32 v153, v153, v145
    v_mul_f32 v154, v154, v146
    v_cvt_pk_bf16_f32 v151, v154, v153
    ds_write_b32 v156, v151 offset:896
    v_readfirstlane_b32 s61, v24
    s_nop 3
    s_add_u32 s61, s61, 0x9e3779b9
    v_lshrrev_b32 v14, 3, v0
    v_lshrrev_b32 v13, 6, v0
    v_and_b32 v154, 7, v0
    v_xor_b32 v13, v13, v154
    v_lshlrev_b32 v13, 4, v13
    v_lshl_add_u32 v13, v14, 7, v13
    v_xor_b32 v153, 64, v13
    v_add_u32 v152, 148480, v13
    v_add_u32 v153, 148480, v153
    v_lshlrev_b32 v154, 4, v154
    v_lshl_add_u32 v154, v14, 12, v154
    s_waitcnt vmcnt(0) lgkmcnt(0)
    s_barrier
    ds_read_b128 v[144:147], v152
    ds_read_b128 v[148:151], v153 offset:4096
    s_lshl_b32 s62, s60, 18
    s_lshl_b32 s63, s59, 7
    s_sub_u32 s62, s62, s63
    s_add_u32 s62, s62, 0x600f80
    s_add_u32 s63, s62, 0x20000
    s_waitcnt lgkmcnt(0)
    buffer_store_dwordx4 v[144:147], v154, s[44:47], s62 offen sc1
    buffer_store_dwordx4 v[148:151], v154, s[44:47], s63 offen sc1
    s_add_u32 s71, s56, 8
    s_lshl_b32 s62, s71, 2
    s_add_u32 s62, s62, 162304
    v_mov_b32 v13, s62
    v_mov_b32 v14, 1
    s_mov_b64 exec, 1
    ds_write_b32 v13, v14
    s_mov_b64 exec, -1
    s_waitcnt vmcnt(0)
    s_lshl_b32 s62, s60, 9
    s_lshl_b32 s63, s59, 4
    s_add_u32 s62, s62, s63
    s_lshl_b32 s63, s56, 2
    s_add_u32 s62, s62, s63
    s_add_u32 s62, s62, 0xb01000
    v_mov_b32 v13, s61
    v_mov_b32 v14, 0
    s_mov_b64 exec, 1
    buffer_store_dword v13, v14, s[44:47], s62 offen sc1
    s_mov_b64 exec, -1
    s_add_u32 s62, s84, 0
    v_mov_b32 v13, s61
    v_mov_b32 v14, 0
    s_mov_b64 exec, 1
    buffer_store_dword v13, v14, s[44:47], s62 offen sc1
    s_mov_b64 exec, -1
    s_add_u32 s62, s84, 128
    v_mov_b32 v13, s61
    v_mov_b32 v14, 0
    s_mov_b64 exec, 1
    buffer_store_dword v13, v14, s[44:47], s62 offen sc1
    s_mov_b64 exec, -1
    s_add_u32 s62, s84, 256
    v_mov_b32 v13, s61
    v_mov_b32 v14, 0
    s_mov_b64 exec, 1
    buffer_store_dword v13, v14, s[44:47], s62 offen sc1
    s_mov_b64 exec, -1
    buffer_load_dwordx4 v[128:131], v2, s[36:39], 0 offen
    v_mov_b32 v140, 0
    s_add_u32 s63, s81, 0
    buffer_load_dwordx4 v[32:35], v2, s[4:7], s63 offen
    s_add_u32 s63, s81, 1024
    buffer_load_dwordx4 v[36:39], v2, s[4:7], s63 offen
    s_add_u32 s63, s81, 2048
    buffer_load_dwordx4 v[40:43], v2, s[4:7], s63 offen
    s_add_u32 s63, s81, 3072
    buffer_load_dwordx4 v[44:47], v2, s[4:7], s63 offen
    s_add_u32 s63, s81, 4096
    buffer_load_dwordx4 v[48:51], v2, s[4:7], s63 offen
    s_add_u32 s63, s81, 5120
    buffer_load_dwordx4 v[52:55], v2, s[4:7], s63 offen
    s_add_u32 s63, s81, 6144
    buffer_load_dwordx4 v[56:59], v2, s[4:7], s63 offen
    s_add_u32 s63, s81, 7168
    buffer_load_dwordx4 v[60:63], v2, s[4:7], s63 offen
    s_add_u32 s63, s81, 8192
    buffer_load_dwordx4 v[64:67], v2, s[4:7], s63 offen
    s_add_u32 s63, s81, 9216
    buffer_load_dwordx4 v[68:71], v2, s[4:7], s63 offen
    s_add_u32 s63, s81, 10240
    buffer_load_dwordx4 v[72:75], v2, s[4:7], s63 offen
    s_add_u32 s63, s81, 11264
    buffer_load_dwordx4 v[76:79], v2, s[4:7], s63 offen
    s_add_u32 s63, s81, 12288
    buffer_load_dwordx4 v[80:83], v2, s[4:7], s63 offen
    s_add_u32 s63, s81, 13312
    buffer_load_dwordx4 v[84:87], v2, s[4:7], s63 offen
    s_add_u32 s63, s81, 14336
    buffer_load_dwordx4 v[88:91], v2, s[4:7], s63 offen
    s_add_u32 s63, s81, 15360
    buffer_load_dwordx4 v[92:95], v2, s[4:7], s63 offen
    s_waitcnt vmcnt(16)
    v_lshlrev_b32 v132, 16, v128
    v_and_b32 v133, s77, v128
    v_lshlrev_b32 v134, 16, v129
    v_and_b32 v135, s77, v129
    v_lshlrev_b32 v136, 16, v130
    v_and_b32 v137, s77, v130
    v_lshlrev_b32 v138, 16, v131
    v_and_b32 v139, s77, v131
    s_waitcnt vmcnt(12)
    v_lshlrev_b32 v144, 16, v32
    v_and_b32 v145, s77, v32
    v_mul_f32 v144, v144, v132
    v_mul_f32 v145, v145, v133
    v_cvt_pk_bf16_f32 v146, v144, v145
    v_lshlrev_b32 v144, 16, v146
    v_and_b32 v145, s77, v146
    v_add_f32 v147, v144, v145
    v_lshlrev_b32 v144, 16, v33
    v_and_b32 v145, s77, v33
    v_mul_f32 v144, v144, v134
    v_mul_f32 v145, v145, v135
    v_cvt_pk_bf16_f32 v146, v144, v145
    v_lshlrev_b32 v144, 16, v146
    v_and_b32 v145, s77, v146
    v_add_f32 v144, v144, v145
    v_add_f32 v147, v147, v144
    v_lshlrev_b32 v144, 16, v34
    v_and_b32 v145, s77, v34
    v_mul_f32 v144, v144, v136
    v_mul_f32 v145, v145, v137
    v_cvt_pk_bf16_f32 v146, v144, v145
    v_lshlrev_b32 v144, 16, v146
    v_and_b32 v145, s77, v146
    v_add_f32 v144, v144, v145
    v_add_f32 v147, v147, v144
    v_lshlrev_b32 v144, 16, v35
    v_and_b32 v145, s77, v35
    v_mul_f32 v144, v144, v138
    v_mul_f32 v145, v145, v139
    v_cvt_pk_bf16_f32 v146, v144, v145
    v_lshlrev_b32 v144, 16, v146
    v_and_b32 v145, s77, v146
    v_add_f32 v144, v144, v145
    v_add_f32 v147, v147, v144
    v_lshlrev_b32 v148, 16, v36
    v_and_b32 v149, s77, v36
    v_mul_f32 v148, v148, v132
    v_mul_f32 v149, v149, v133
    v_cvt_pk_bf16_f32 v150, v148, v149
    v_lshlrev_b32 v148, 16, v150
    v_and_b32 v149, s77, v150
    v_add_f32 v151, v148, v149
    v_lshlrev_b32 v148, 16, v37
    v_and_b32 v149, s77, v37
    v_mul_f32 v148, v148, v134
    v_mul_f32 v149, v149, v135
    v_cvt_pk_bf16_f32 v150, v148, v149
    v_lshlrev_b32 v148, 16, v150
    v_and_b32 v149, s77, v150
    v_add_f32 v148, v148, v149
    v_add_f32 v151, v151, v148
    v_lshlrev_b32 v148, 16, v38
    v_and_b32 v149, s77, v38
    v_mul_f32 v148, v148, v136
    v_mul_f32 v149, v149, v137
    v_cvt_pk_bf16_f32 v150, v148, v149
    v_lshlrev_b32 v148, 16, v150
    v_and_b32 v149, s77, v150
    v_add_f32 v148, v148, v149
    v_add_f32 v151, v151, v148
    v_lshlrev_b32 v148, 16, v39
    v_and_b32 v149, s77, v39
    v_mul_f32 v148, v148, v138
    v_mul_f32 v149, v149, v139
    v_cvt_pk_bf16_f32 v150, v148, v149
    v_lshlrev_b32 v148, 16, v150
    v_and_b32 v149, s77, v150
    v_add_f32 v148, v148, v149
    v_add_f32 v151, v151, v148
    v_lshlrev_b32 v152, 16, v40
    v_and_b32 v153, s77, v40
    v_mul_f32 v152, v152, v132
    v_mul_f32 v153, v153, v133
    v_cvt_pk_bf16_f32 v154, v152, v153
    v_lshlrev_b32 v152, 16, v154
    v_and_b32 v153, s77, v154
    v_add_f32 v155, v152, v153
    v_lshlrev_b32 v152, 16, v41
    v_and_b32 v153, s77, v41
    v_mul_f32 v152, v152, v134
    v_mul_f32 v153, v153, v135
    v_cvt_pk_bf16_f32 v154, v152, v153
    v_lshlrev_b32 v152, 16, v154
    v_and_b32 v153, s77, v154
    v_add_f32 v152, v152, v153
    v_add_f32 v155, v155, v152
    v_lshlrev_b32 v152, 16, v42
    v_and_b32 v153, s77, v42
    v_mul_f32 v152, v152, v136
    v_mul_f32 v153, v153, v137
    v_cvt_pk_bf16_f32 v154, v152, v153
    v_lshlrev_b32 v152, 16, v154
    v_and_b32 v153, s77, v154
    v_add_f32 v152, v152, v153
    v_add_f32 v155, v155, v152
    v_lshlrev_b32 v152, 16, v43
    v_and_b32 v153, s77, v43
    v_mul_f32 v152, v152, v138
    v_mul_f32 v153, v153, v139
    v_cvt_pk_bf16_f32 v154, v152, v153
    v_lshlrev_b32 v152, 16, v154
    v_and_b32 v153, s77, v154
    v_add_f32 v152, v152, v153
    v_add_f32 v155, v155, v152
    v_lshlrev_b32 v156, 16, v44
    v_and_b32 v157, s77, v44
    v_mul_f32 v156, v156, v132
    v_mul_f32 v157, v157, v133
    v_cvt_pk_bf16_f32 v158, v156, v157
    v_lshlrev_b32 v156, 16, v158
    v_and_b32 v157, s77, v158
    v_add_f32 v159, v156, v157
    v_lshlrev_b32 v156, 16, v45
    v_and_b32 v157, s77, v45
    v_mul_f32 v156, v156, v134
    v_mul_f32 v157, v157, v135
    v_cvt_pk_bf16_f32 v158, v156, v157
    v_lshlrev_b32 v156, 16, v158
    v_and_b32 v157, s77, v158
    v_add_f32 v156, v156, v157
    v_add_f32 v159, v159, v156
    v_lshlrev_b32 v156, 16, v46
    v_and_b32 v157, s77, v46
    v_mul_f32 v156, v156, v136
    v_mul_f32 v157, v157, v137
    v_cvt_pk_bf16_f32 v158, v156, v157
    v_lshlrev_b32 v156, 16, v158
    v_and_b32 v157, s77, v158
    v_add_f32 v156, v156, v157
    v_add_f32 v159, v159, v156
    v_lshlrev_b32 v156, 16, v47
    v_and_b32 v157, s77, v47
    v_mul_f32 v156, v156, v138
    v_mul_f32 v157, v157, v139
    v_cvt_pk_bf16_f32 v158, v156, v157
    v_lshlrev_b32 v156, 16, v158
    v_and_b32 v157, s77, v158
    v_add_f32 v156, v156, v157
    v_add_f32 v159, v159, v156
    v_add_f32_dpp v147, v147, v147 row_shr:1 row_mask:0xf bank_mask:0xf bound_ctrl:0
    v_add_f32_dpp v151, v151, v151 row_shr:1 row_mask:0xf bank_mask:0xf bound_ctrl:0
    v_add_f32_dpp v155, v155, v155 row_shr:1 row_mask:0xf bank_mask:0xf bound_ctrl:0
    v_add_f32_dpp v159, v159, v159 row_shr:1 row_mask:0xf bank_mask:0xf bound_ctrl:0
    v_add_f32_dpp v147, v147, v147 row_shr:2 row_mask:0xf bank_mask:0xf bound_ctrl:0
    v_add_f32_dpp v151, v151, v151 row_shr:2 row_mask:0xf bank_mask:0xf bound_ctrl:0
    v_add_f32_dpp v155, v155, v155 row_shr:2 row_mask:0xf bank_mask:0xf bound_ctrl:0
    v_add_f32_dpp v159, v159, v159 row_shr:2 row_mask:0xf bank_mask:0xf bound_ctrl:0
    v_add_f32_dpp v147, v147, v147 row_shr:4 row_mask:0xf bank_mask:0xf bound_ctrl:0
    v_add_f32_dpp v151, v151, v151 row_shr:4 row_mask:0xf bank_mask:0xf bound_ctrl:0
    v_add_f32_dpp v155, v155, v155 row_shr:4 row_mask:0xf bank_mask:0xf bound_ctrl:0
    v_add_f32_dpp v159, v159, v159 row_shr:4 row_mask:0xf bank_mask:0xf bound_ctrl:0
    v_add_f32_dpp v147, v147, v147 row_shr:8 row_mask:0xf bank_mask:0xf bound_ctrl:0
    v_add_f32_dpp v151, v151, v151 row_shr:8 row_mask:0xf bank_mask:0xf bound_ctrl:0
    v_add_f32_dpp v155, v155, v155 row_shr:8 row_mask:0xf bank_mask:0xf bound_ctrl:0
    v_add_f32_dpp v159, v159, v159 row_shr:8 row_mask:0xf bank_mask:0xf bound_ctrl:0
    v_add_f32_dpp v147, v147, v147 row_bcast:15 row_mask:0xa bank_mask:0xf
    v_add_f32_dpp v151, v151, v151 row_bcast:15 row_mask:0xa bank_mask:0xf
    v_add_f32_dpp v155, v155, v155 row_bcast:15 row_mask:0xa bank_mask:0xf
    v_add_f32_dpp v159, v159, v159 row_bcast:15 row_mask:0xa bank_mask:0xf
    v_add_f32_dpp v147, v147, v147 row_bcast:31 row_mask:0xc bank_mask:0xf
    v_add_f32_dpp v151, v151, v151 row_bcast:31 row_mask:0xc bank_mask:0xf
    v_add_f32_dpp v155, v155, v155 row_bcast:31 row_mask:0xc bank_mask:0xf
    v_add_f32_dpp v159, v159, v159 row_bcast:31 row_mask:0xc bank_mask:0xf
    v_readlane_b32 s64, v147, 63
    v_readlane_b32 s65, v151, 63
    v_readlane_b32 s66, v155, 63
    v_readlane_b32 s67, v159, 63
    s_nop 0
    v_writelane_b32 v140, s64, 0
    v_writelane_b32 v140, s65, 1
    v_writelane_b32 v140, s66, 2
    v_writelane_b32 v140, s67, 3
    s_waitcnt vmcnt(8)
    v_lshlrev_b32 v144, 16, v48
    v_and_b32 v145, s77, v48
    v_mul_f32 v144, v144, v132
    v_mul_f32 v145, v145, v133
    v_cvt_pk_bf16_f32 v146, v144, v145
    v_lshlrev_b32 v144, 16, v146
    v_and_b32 v145, s77, v146
    v_add_f32 v147, v144, v145
    v_lshlrev_b32 v144, 16, v49
    v_and_b32 v145, s77, v49
    v_mul_f32 v144, v144, v134
    v_mul_f32 v145, v145, v135
    v_cvt_pk_bf16_f32 v146, v144, v145
    v_lshlrev_b32 v144, 16, v146
    v_and_b32 v145, s77, v146
    v_add_f32 v144, v144, v145
    v_add_f32 v147, v147, v144
    v_lshlrev_b32 v144, 16, v50
    v_and_b32 v145, s77, v50
    v_mul_f32 v144, v144, v136
    v_mul_f32 v145, v145, v137
    v_cvt_pk_bf16_f32 v146, v144, v145
    v_lshlrev_b32 v144, 16, v146
    v_and_b32 v145, s77, v146
    v_add_f32 v144, v144, v145
    v_add_f32 v147, v147, v144
    v_lshlrev_b32 v144, 16, v51
    v_and_b32 v145, s77, v51
    v_mul_f32 v144, v144, v138
    v_mul_f32 v145, v145, v139
    v_cvt_pk_bf16_f32 v146, v144, v145
    v_lshlrev_b32 v144, 16, v146
    v_and_b32 v145, s77, v146
    v_add_f32 v144, v144, v145
    v_add_f32 v147, v147, v144
    v_lshlrev_b32 v148, 16, v52
    v_and_b32 v149, s77, v52
    v_mul_f32 v148, v148, v132
    v_mul_f32 v149, v149, v133
    v_cvt_pk_bf16_f32 v150, v148, v149
    v_lshlrev_b32 v148, 16, v150
    v_and_b32 v149, s77, v150
    v_add_f32 v151, v148, v149
    v_lshlrev_b32 v148, 16, v53
    v_and_b32 v149, s77, v53
    v_mul_f32 v148, v148, v134
    v_mul_f32 v149, v149, v135
    v_cvt_pk_bf16_f32 v150, v148, v149
    v_lshlrev_b32 v148, 16, v150
    v_and_b32 v149, s77, v150
    v_add_f32 v148, v148, v149
    v_add_f32 v151, v151, v148
    v_lshlrev_b32 v148, 16, v54
    v_and_b32 v149, s77, v54
    v_mul_f32 v148, v148, v136
    v_mul_f32 v149, v149, v137
    v_cvt_pk_bf16_f32 v150, v148, v149
    v_lshlrev_b32 v148, 16, v150
    v_and_b32 v149, s77, v150
    v_add_f32 v148, v148, v149
    v_add_f32 v151, v151, v148
    v_lshlrev_b32 v148, 16, v55
    v_and_b32 v149, s77, v55
    v_mul_f32 v148, v148, v138
    v_mul_f32 v149, v149, v139
    v_cvt_pk_bf16_f32 v150, v148, v149
    v_lshlrev_b32 v148, 16, v150
    v_and_b32 v149, s77, v150
    v_add_f32 v148, v148, v149
    v_add_f32 v151, v151, v148
    v_lshlrev_b32 v152, 16, v56
    v_and_b32 v153, s77, v56
    v_mul_f32 v152, v152, v132
    v_mul_f32 v153, v153, v133
    v_cvt_pk_bf16_f32 v154, v152, v153
    v_lshlrev_b32 v152, 16, v154
    v_and_b32 v153, s77, v154
    v_add_f32 v155, v152, v153
    v_lshlrev_b32 v152, 16, v57
    v_and_b32 v153, s77, v57
    v_mul_f32 v152, v152, v134
    v_mul_f32 v153, v153, v135
    v_cvt_pk_bf16_f32 v154, v152, v153
    v_lshlrev_b32 v152, 16, v154
    v_and_b32 v153, s77, v154
    v_add_f32 v152, v152, v153
    v_add_f32 v155, v155, v152
    v_lshlrev_b32 v152, 16, v58
    v_and_b32 v153, s77, v58
    v_mul_f32 v152, v152, v136
    v_mul_f32 v153, v153, v137
    v_cvt_pk_bf16_f32 v154, v152, v153
    v_lshlrev_b32 v152, 16, v154
    v_and_b32 v153, s77, v154
    v_add_f32 v152, v152, v153
    v_add_f32 v155, v155, v152
    v_lshlrev_b32 v152, 16, v59
    v_and_b32 v153, s77, v59
    v_mul_f32 v152, v152, v138
    v_mul_f32 v153, v153, v139
    v_cvt_pk_bf16_f32 v154, v152, v153
    v_lshlrev_b32 v152, 16, v154
    v_and_b32 v153, s77, v154
    v_add_f32 v152, v152, v153
    v_add_f32 v155, v155, v152
    v_lshlrev_b32 v156, 16, v60
    v_and_b32 v157, s77, v60
    v_mul_f32 v156, v156, v132
    v_mul_f32 v157, v157, v133
    v_cvt_pk_bf16_f32 v158, v156, v157
    v_lshlrev_b32 v156, 16, v158
    v_and_b32 v157, s77, v158
    v_add_f32 v159, v156, v157
    v_lshlrev_b32 v156, 16, v61
    v_and_b32 v157, s77, v61
    v_mul_f32 v156, v156, v134
    v_mul_f32 v157, v157, v135
    v_cvt_pk_bf16_f32 v158, v156, v157
    v_lshlrev_b32 v156, 16, v158
    v_and_b32 v157, s77, v158
    v_add_f32 v156, v156, v157
    v_add_f32 v159, v159, v156
    v_lshlrev_b32 v156, 16, v62
    v_and_b32 v157, s77, v62
    v_mul_f32 v156, v156, v136
    v_mul_f32 v157, v157, v137
    v_cvt_pk_bf16_f32 v158, v156, v157
    v_lshlrev_b32 v156, 16, v158
    v_and_b32 v157, s77, v158
    v_add_f32 v156, v156, v157
    v_add_f32 v159, v159, v156
    v_lshlrev_b32 v156, 16, v63
    v_and_b32 v157, s77, v63
    v_mul_f32 v156, v156, v138
    v_mul_f32 v157, v157, v139
    v_cvt_pk_bf16_f32 v158, v156, v157
    v_lshlrev_b32 v156, 16, v158
    v_and_b32 v157, s77, v158
    v_add_f32 v156, v156, v157
    v_add_f32 v159, v159, v156
    v_add_f32_dpp v147, v147, v147 row_shr:1 row_mask:0xf bank_mask:0xf bound_ctrl:0
    v_add_f32_dpp v151, v151, v151 row_shr:1 row_mask:0xf bank_mask:0xf bound_ctrl:0
    v_add_f32_dpp v155, v155, v155 row_shr:1 row_mask:0xf bank_mask:0xf bound_ctrl:0
    v_add_f32_dpp v159, v159, v159 row_shr:1 row_mask:0xf bank_mask:0xf bound_ctrl:0
    v_add_f32_dpp v147, v147, v147 row_shr:2 row_mask:0xf bank_mask:0xf bound_ctrl:0
    v_add_f32_dpp v151, v151, v151 row_shr:2 row_mask:0xf bank_mask:0xf bound_ctrl:0
    v_add_f32_dpp v155, v155, v155 row_shr:2 row_mask:0xf bank_mask:0xf bound_ctrl:0
    v_add_f32_dpp v159, v159, v159 row_shr:2 row_mask:0xf bank_mask:0xf bound_ctrl:0
    v_add_f32_dpp v147, v147, v147 row_shr:4 row_mask:0xf bank_mask:0xf bound_ctrl:0
    v_add_f32_dpp v151, v151, v151 row_shr:4 row_mask:0xf bank_mask:0xf bound_ctrl:0
    v_add_f32_dpp v155, v155, v155 row_shr:4 row_mask:0xf bank_mask:0xf bound_ctrl:0
    v_add_f32_dpp v159, v159, v159 row_shr:4 row_mask:0xf bank_mask:0xf bound_ctrl:0
    v_add_f32_dpp v147, v147, v147 row_shr:8 row_mask:0xf bank_mask:0xf bound_ctrl:0
    v_add_f32_dpp v151, v151, v151 row_shr:8 row_mask:0xf bank_mask:0xf bound_ctrl:0
    v_add_f32_dpp v155, v155, v155 row_shr:8 row_mask:0xf bank_mask:0xf bound_ctrl:0
    v_add_f32_dpp v159, v159, v159 row_shr:8 row_mask:0xf bank_mask:0xf bound_ctrl:0
    v_add_f32_dpp v147, v147, v147 row_bcast:15 row_mask:0xa bank_mask:0xf
    v_add_f32_dpp v151, v151, v151 row_bcast:15 row_mask:0xa bank_mask:0xf
    v_add_f32_dpp v155, v155, v155 row_bcast:15 row_mask:0xa bank_mask:0xf
    v_add_f32_dpp v159, v159, v159 row_bcast:15 row_mask:0xa bank_mask:0xf
    v_add_f32_dpp v147, v147, v147 row_bcast:31 row_mask:0xc bank_mask:0xf
    v_add_f32_dpp v151, v151, v151 row_bcast:31 row_mask:0xc bank_mask:0xf
    v_add_f32_dpp v155, v155, v155 row_bcast:31 row_mask:0xc bank_mask:0xf
    v_add_f32_dpp v159, v159, v159 row_bcast:31 row_mask:0xc bank_mask:0xf
    v_readlane_b32 s64, v147, 63
    v_readlane_b32 s65, v151, 63
    v_readlane_b32 s66, v155, 63
    v_readlane_b32 s67, v159, 63
    s_nop 0
    v_writelane_b32 v140, s64, 4
    v_writelane_b32 v140, s65, 5
    v_writelane_b32 v140, s66, 6
    v_writelane_b32 v140, s67, 7
    s_waitcnt vmcnt(4)
    v_lshlrev_b32 v144, 16, v64
    v_and_b32 v145, s77, v64
    v_mul_f32 v144, v144, v132
    v_mul_f32 v145, v145, v133
    v_cvt_pk_bf16_f32 v146, v144, v145
    v_lshlrev_b32 v144, 16, v146
    v_and_b32 v145, s77, v146
    v_add_f32 v147, v144, v145
    v_lshlrev_b32 v144, 16, v65
    v_and_b32 v145, s77, v65
    v_mul_f32 v144, v144, v134
    v_mul_f32 v145, v145, v135
    v_cvt_pk_bf16_f32 v146, v144, v145
    v_lshlrev_b32 v144, 16, v146
    v_and_b32 v145, s77, v146
    v_add_f32 v144, v144, v145
    v_add_f32 v147, v147, v144
    v_lshlrev_b32 v144, 16, v66
    v_and_b32 v145, s77, v66
    v_mul_f32 v144, v144, v136
    v_mul_f32 v145, v145, v137
    v_cvt_pk_bf16_f32 v146, v144, v145
    v_lshlrev_b32 v144, 16, v146
    v_and_b32 v145, s77, v146
    v_add_f32 v144, v144, v145
    v_add_f32 v147, v147, v144
    v_lshlrev_b32 v144, 16, v67
    v_and_b32 v145, s77, v67
    v_mul_f32 v144, v144, v138
    v_mul_f32 v145, v145, v139
    v_cvt_pk_bf16_f32 v146, v144, v145
    v_lshlrev_b32 v144, 16, v146
    v_and_b32 v145, s77, v146
    v_add_f32 v144, v144, v145
    v_add_f32 v147, v147, v144
    v_lshlrev_b32 v148, 16, v68
    v_and_b32 v149, s77, v68
    v_mul_f32 v148, v148, v132
    v_mul_f32 v149, v149, v133
    v_cvt_pk_bf16_f32 v150, v148, v149
    v_lshlrev_b32 v148, 16, v150
    v_and_b32 v149, s77, v150
    v_add_f32 v151, v148, v149
    v_lshlrev_b32 v148, 16, v69
    v_and_b32 v149, s77, v69
    v_mul_f32 v148, v148, v134
    v_mul_f32 v149, v149, v135
    v_cvt_pk_bf16_f32 v150, v148, v149
    v_lshlrev_b32 v148, 16, v150
    v_and_b32 v149, s77, v150
    v_add_f32 v148, v148, v149
    v_add_f32 v151, v151, v148
    v_lshlrev_b32 v148, 16, v70
    v_and_b32 v149, s77, v70
    v_mul_f32 v148, v148, v136
    v_mul_f32 v149, v149, v137
    v_cvt_pk_bf16_f32 v150, v148, v149
    v_lshlrev_b32 v148, 16, v150
    v_and_b32 v149, s77, v150
    v_add_f32 v148, v148, v149
    v_add_f32 v151, v151, v148
    v_lshlrev_b32 v148, 16, v71
    v_and_b32 v149, s77, v71
    v_mul_f32 v148, v148, v138
    v_mul_f32 v149, v149, v139
    v_cvt_pk_bf16_f32 v150, v148, v149
    v_lshlrev_b32 v148, 16, v150
    v_and_b32 v149, s77, v150
    v_add_f32 v148, v148, v149
    v_add_f32 v151, v151, v148
    v_lshlrev_b32 v152, 16, v72
    v_and_b32 v153, s77, v72
    v_mul_f32 v152, v152, v132
    v_mul_f32 v153, v153, v133
    v_cvt_pk_bf16_f32 v154, v152, v153
    v_lshlrev_b32 v152, 16, v154
    v_and_b32 v153, s77, v154
    v_add_f32 v155, v152, v153
    v_lshlrev_b32 v152, 16, v73
    v_and_b32 v153, s77, v73
    v_mul_f32 v152, v152, v134
    v_mul_f32 v153, v153, v135
    v_cvt_pk_bf16_f32 v154, v152, v153
    v_lshlrev_b32 v152, 16, v154
    v_and_b32 v153, s77, v154
    v_add_f32 v152, v152, v153
    v_add_f32 v155, v155, v152
    v_lshlrev_b32 v152, 16, v74
    v_and_b32 v153, s77, v74
    v_mul_f32 v152, v152, v136
    v_mul_f32 v153, v153, v137
    v_cvt_pk_bf16_f32 v154, v152, v153
    v_lshlrev_b32 v152, 16, v154
    v_and_b32 v153, s77, v154
    v_add_f32 v152, v152, v153
    v_add_f32 v155, v155, v152
    v_lshlrev_b32 v152, 16, v75
    v_and_b32 v153, s77, v75
    v_mul_f32 v152, v152, v138
    v_mul_f32 v153, v153, v139
    v_cvt_pk_bf16_f32 v154, v152, v153
    v_lshlrev_b32 v152, 16, v154
    v_and_b32 v153, s77, v154
    v_add_f32 v152, v152, v153
    v_add_f32 v155, v155, v152
    v_lshlrev_b32 v156, 16, v76
    v_and_b32 v157, s77, v76
    v_mul_f32 v156, v156, v132
    v_mul_f32 v157, v157, v133
    v_cvt_pk_bf16_f32 v158, v156, v157
    v_lshlrev_b32 v156, 16, v158
    v_and_b32 v157, s77, v158
    v_add_f32 v159, v156, v157
    v_lshlrev_b32 v156, 16, v77
    v_and_b32 v157, s77, v77
    v_mul_f32 v156, v156, v134
    v_mul_f32 v157, v157, v135
    v_cvt_pk_bf16_f32 v158, v156, v157
    v_lshlrev_b32 v156, 16, v158
    v_and_b32 v157, s77, v158
    v_add_f32 v156, v156, v157
    v_add_f32 v159, v159, v156
    v_lshlrev_b32 v156, 16, v78
    v_and_b32 v157, s77, v78
    v_mul_f32 v156, v156, v136
    v_mul_f32 v157, v157, v137
    v_cvt_pk_bf16_f32 v158, v156, v157
    v_lshlrev_b32 v156, 16, v158
    v_and_b32 v157, s77, v158
    v_add_f32 v156, v156, v157
    v_add_f32 v159, v159, v156
    v_lshlrev_b32 v156, 16, v79
    v_and_b32 v157, s77, v79
    v_mul_f32 v156, v156, v138
    v_mul_f32 v157, v157, v139
    v_cvt_pk_bf16_f32 v158, v156, v157
    v_lshlrev_b32 v156, 16, v158
    v_and_b32 v157, s77, v158
    v_add_f32 v156, v156, v157
    v_add_f32 v159, v159, v156
    v_add_f32_dpp v147, v147, v147 row_shr:1 row_mask:0xf bank_mask:0xf bound_ctrl:0
    v_add_f32_dpp v151, v151, v151 row_shr:1 row_mask:0xf bank_mask:0xf bound_ctrl:0
    v_add_f32_dpp v155, v155, v155 row_shr:1 row_mask:0xf bank_mask:0xf bound_ctrl:0
    v_add_f32_dpp v159, v159, v159 row_shr:1 row_mask:0xf bank_mask:0xf bound_ctrl:0
    v_add_f32_dpp v147, v147, v147 row_shr:2 row_mask:0xf bank_mask:0xf bound_ctrl:0
    v_add_f32_dpp v151, v151, v151 row_shr:2 row_mask:0xf bank_mask:0xf bound_ctrl:0
    v_add_f32_dpp v155, v155, v155 row_shr:2 row_mask:0xf bank_mask:0xf bound_ctrl:0
    v_add_f32_dpp v159, v159, v159 row_shr:2 row_mask:0xf bank_mask:0xf bound_ctrl:0
    v_add_f32_dpp v147, v147, v147 row_shr:4 row_mask:0xf bank_mask:0xf bound_ctrl:0
    v_add_f32_dpp v151, v151, v151 row_shr:4 row_mask:0xf bank_mask:0xf bound_ctrl:0
    v_add_f32_dpp v155, v155, v155 row_shr:4 row_mask:0xf bank_mask:0xf bound_ctrl:0
    v_add_f32_dpp v159, v159, v159 row_shr:4 row_mask:0xf bank_mask:0xf bound_ctrl:0
    v_add_f32_dpp v147, v147, v147 row_shr:8 row_mask:0xf bank_mask:0xf bound_ctrl:0
    v_add_f32_dpp v151, v151, v151 row_shr:8 row_mask:0xf bank_mask:0xf bound_ctrl:0
    v_add_f32_dpp v155, v155, v155 row_shr:8 row_mask:0xf bank_mask:0xf bound_ctrl:0
    v_add_f32_dpp v159, v159, v159 row_shr:8 row_mask:0xf bank_mask:0xf bound_ctrl:0
    v_add_f32_dpp v147, v147, v147 row_bcast:15 row_mask:0xa bank_mask:0xf
    v_add_f32_dpp v151, v151, v151 row_bcast:15 row_mask:0xa bank_mask:0xf
    v_add_f32_dpp v155, v155, v155 row_bcast:15 row_mask:0xa bank_mask:0xf
    v_add_f32_dpp v159, v159, v159 row_bcast:15 row_mask:0xa bank_mask:0xf
    v_add_f32_dpp v147, v147, v147 row_bcast:31 row_mask:0xc bank_mask:0xf
    v_add_f32_dpp v151, v151, v151 row_bcast:31 row_mask:0xc bank_mask:0xf
    v_add_f32_dpp v155, v155, v155 row_bcast:31 row_mask:0xc bank_mask:0xf
    v_add_f32_dpp v159, v159, v159 row_bcast:31 row_mask:0xc bank_mask:0xf
    v_readlane_b32 s64, v147, 63
    v_readlane_b32 s65, v151, 63
    v_readlane_b32 s66, v155, 63
    v_readlane_b32 s67, v159, 63
    s_nop 0
    v_writelane_b32 v140, s64, 8
    v_writelane_b32 v140, s65, 9
    v_writelane_b32 v140, s66, 10
    v_writelane_b32 v140, s67, 11
    s_waitcnt vmcnt(0)
    v_lshlrev_b32 v144, 16, v80
    v_and_b32 v145, s77, v80
    v_mul_f32 v144, v144, v132
    v_mul_f32 v145, v145, v133
    v_cvt_pk_bf16_f32 v146, v144, v145
    v_lshlrev_b32 v144, 16, v146
    v_and_b32 v145, s77, v146
    v_add_f32 v147, v144, v145
    v_lshlrev_b32 v144, 16, v81
    v_and_b32 v145, s77, v81
    v_mul_f32 v144, v144, v134
    v_mul_f32 v145, v145, v135
    v_cvt_pk_bf16_f32 v146, v144, v145
    v_lshlrev_b32 v144, 16, v146
    v_and_b32 v145, s77, v146
    v_add_f32 v144, v144, v145
    v_add_f32 v147, v147, v144
    v_lshlrev_b32 v144, 16, v82
    v_and_b32 v145, s77, v82
    v_mul_f32 v144, v144, v136
    v_mul_f32 v145, v145, v137
    v_cvt_pk_bf16_f32 v146, v144, v145
    v_lshlrev_b32 v144, 16, v146
    v_and_b32 v145, s77, v146
    v_add_f32 v144, v144, v145
    v_add_f32 v147, v147, v144
    v_lshlrev_b32 v144, 16, v83
    v_and_b32 v145, s77, v83
    v_mul_f32 v144, v144, v138
    v_mul_f32 v145, v145, v139
    v_cvt_pk_bf16_f32 v146, v144, v145
    v_lshlrev_b32 v144, 16, v146
    v_and_b32 v145, s77, v146
    v_add_f32 v144, v144, v145
    v_add_f32 v147, v147, v144
    v_lshlrev_b32 v148, 16, v84
    v_and_b32 v149, s77, v84
    v_mul_f32 v148, v148, v132
    v_mul_f32 v149, v149, v133
    v_cvt_pk_bf16_f32 v150, v148, v149
    v_lshlrev_b32 v148, 16, v150
    v_and_b32 v149, s77, v150
    v_add_f32 v151, v148, v149
    v_lshlrev_b32 v148, 16, v85
    v_and_b32 v149, s77, v85
    v_mul_f32 v148, v148, v134
    v_mul_f32 v149, v149, v135
    v_cvt_pk_bf16_f32 v150, v148, v149
    v_lshlrev_b32 v148, 16, v150
    v_and_b32 v149, s77, v150
    v_add_f32 v148, v148, v149
    v_add_f32 v151, v151, v148
    v_lshlrev_b32 v148, 16, v86
    v_and_b32 v149, s77, v86
    v_mul_f32 v148, v148, v136
    v_mul_f32 v149, v149, v137
    v_cvt_pk_bf16_f32 v150, v148, v149
    v_lshlrev_b32 v148, 16, v150
    v_and_b32 v149, s77, v150
    v_add_f32 v148, v148, v149
    v_add_f32 v151, v151, v148
    v_lshlrev_b32 v148, 16, v87
    v_and_b32 v149, s77, v87
    v_mul_f32 v148, v148, v138
    v_mul_f32 v149, v149, v139
    v_cvt_pk_bf16_f32 v150, v148, v149
    v_lshlrev_b32 v148, 16, v150
    v_and_b32 v149, s77, v150
    v_add_f32 v148, v148, v149
    v_add_f32 v151, v151, v148
    v_lshlrev_b32 v152, 16, v88
    v_and_b32 v153, s77, v88
    v_mul_f32 v152, v152, v132
    v_mul_f32 v153, v153, v133
    v_cvt_pk_bf16_f32 v154, v152, v153
    v_lshlrev_b32 v152, 16, v154
    v_and_b32 v153, s77, v154
    v_add_f32 v155, v152, v153
    v_lshlrev_b32 v152, 16, v89
    v_and_b32 v153, s77, v89
    v_mul_f32 v152, v152, v134
    v_mul_f32 v153, v153, v135
    v_cvt_pk_bf16_f32 v154, v152, v153
    v_lshlrev_b32 v152, 16, v154
    v_and_b32 v153, s77, v154
    v_add_f32 v152, v152, v153
    v_add_f32 v155, v155, v152
    v_lshlrev_b32 v152, 16, v90
    v_and_b32 v153, s77, v90
    v_mul_f32 v152, v152, v136
    v_mul_f32 v153, v153, v137
    v_cvt_pk_bf16_f32 v154, v152, v153
    v_lshlrev_b32 v152, 16, v154
    v_and_b32 v153, s77, v154
    v_add_f32 v152, v152, v153
    v_add_f32 v155, v155, v152
    v_lshlrev_b32 v152, 16, v91
    v_and_b32 v153, s77, v91
    v_mul_f32 v152, v152, v138
    v_mul_f32 v153, v153, v139
    v_cvt_pk_bf16_f32 v154, v152, v153
    v_lshlrev_b32 v152, 16, v154
    v_and_b32 v153, s77, v154
    v_add_f32 v152, v152, v153
    v_add_f32 v155, v155, v152
    v_lshlrev_b32 v156, 16, v92
    v_and_b32 v157, s77, v92
    v_mul_f32 v156, v156, v132
    v_mul_f32 v157, v157, v133
    v_cvt_pk_bf16_f32 v158, v156, v157
    v_lshlrev_b32 v156, 16, v158
    v_and_b32 v157, s77, v158
    v_add_f32 v159, v156, v157
    v_lshlrev_b32 v156, 16, v93
    v_and_b32 v157, s77, v93
    v_mul_f32 v156, v156, v134
    v_mul_f32 v157, v157, v135
    v_cvt_pk_bf16_f32 v158, v156, v157
    v_lshlrev_b32 v156, 16, v158
    v_and_b32 v157, s77, v158
    v_add_f32 v156, v156, v157
    v_add_f32 v159, v159, v156
    v_lshlrev_b32 v156, 16, v94
    v_and_b32 v157, s77, v94
    v_mul_f32 v156, v156, v136
    v_mul_f32 v157, v157, v137
    v_cvt_pk_bf16_f32 v158, v156, v157
    v_lshlrev_b32 v156, 16, v158
    v_and_b32 v157, s77, v158
    v_add_f32 v156, v156, v157
    v_add_f32 v159, v159, v156
    v_lshlrev_b32 v156, 16, v95
    v_and_b32 v157, s77, v95
    v_mul_f32 v156, v156, v138
    v_mul_f32 v157, v157, v139
    v_cvt_pk_bf16_f32 v158, v156, v157
    v_lshlrev_b32 v156, 16, v158
    v_and_b32 v157, s77, v158
    v_add_f32 v156, v156, v157
    v_add_f32 v159, v159, v156
    v_add_f32_dpp v147, v147, v147 row_shr:1 row_mask:0xf bank_mask:0xf bound_ctrl:0
    v_add_f32_dpp v151, v151, v151 row_shr:1 row_mask:0xf bank_mask:0xf bound_ctrl:0
    v_add_f32_dpp v155, v155, v155 row_shr:1 row_mask:0xf bank_mask:0xf bound_ctrl:0
    v_add_f32_dpp v159, v159, v159 row_shr:1 row_mask:0xf bank_mask:0xf bound_ctrl:0
    v_add_f32_dpp v147, v147, v147 row_shr:2 row_mask:0xf bank_mask:0xf bound_ctrl:0
    v_add_f32_dpp v151, v151, v151 row_shr:2 row_mask:0xf bank_mask:0xf bound_ctrl:0
    v_add_f32_dpp v155, v155, v155 row_shr:2 row_mask:0xf bank_mask:0xf bound_ctrl:0
    v_add_f32_dpp v159, v159, v159 row_shr:2 row_mask:0xf bank_mask:0xf bound_ctrl:0
    v_add_f32_dpp v147, v147, v147 row_shr:4 row_mask:0xf bank_mask:0xf bound_ctrl:0
    v_add_f32_dpp v151, v151, v151 row_shr:4 row_mask:0xf bank_mask:0xf bound_ctrl:0
    v_add_f32_dpp v155, v155, v155 row_shr:4 row_mask:0xf bank_mask:0xf bound_ctrl:0
    v_add_f32_dpp v159, v159, v159 row_shr:4 row_mask:0xf bank_mask:0xf bound_ctrl:0
    v_add_f32_dpp v147, v147, v147 row_shr:8 row_mask:0xf bank_mask:0xf bound_ctrl:0
    v_add_f32_dpp v151, v151, v151 row_shr:8 row_mask:0xf bank_mask:0xf bound_ctrl:0
    v_add_f32_dpp v155, v155, v155 row_shr:8 row_mask:0xf bank_mask:0xf bound_ctrl:0
    v_add_f32_dpp v159, v159, v159 row_shr:8 row_mask:0xf bank_mask:0xf bound_ctrl:0
    v_add_f32_dpp v147, v147, v147 row_bcast:15 row_mask:0xa bank_mask:0xf
    v_add_f32_dpp v151, v151, v151 row_bcast:15 row_mask:0xa bank_mask:0xf
    v_add_f32_dpp v155, v155, v155 row_bcast:15 row_mask:0xa bank_mask:0xf
    v_add_f32_dpp v159, v159, v159 row_bcast:15 row_mask:0xa bank_mask:0xf
    v_add_f32_dpp v147, v147, v147 row_bcast:31 row_mask:0xc bank_mask:0xf
    v_add_f32_dpp v151, v151, v151 row_bcast:31 row_mask:0xc bank_mask:0xf
    v_add_f32_dpp v155, v155, v155 row_bcast:31 row_mask:0xc bank_mask:0xf
    v_add_f32_dpp v159, v159, v159 row_bcast:31 row_mask:0xc bank_mask:0xf
    v_readlane_b32 s64, v147, 63
    v_readlane_b32 s65, v151, 63
    v_readlane_b32 s66, v155, 63
    v_readlane_b32 s67, v159, 63
    s_nop 0
    v_writelane_b32 v140, s64, 12
    v_writelane_b32 v140, s65, 13
    v_writelane_b32 v140, s66, 14
    v_writelane_b32 v140, s67, 15
    s_add_u32 s63, s81, 16384
    buffer_load_dwordx4 v[32:35], v2, s[4:7], s63 offen
    s_add_u32 s63, s81, 17408
    buffer_load_dwordx4 v[36:39], v2, s[4:7], s63 offen
    s_add_u32 s63, s81, 18432
    buffer_load_dwordx4 v[40:43], v2, s[4:7], s63 offen
    s_add_u32 s63, s81, 19456
    buffer_load_dwordx4 v[44:47], v2, s[4:7], s63 offen
    s_add_u32 s63, s81, 20480
    buffer_load_dwordx4 v[48:51], v2, s[4:7], s63 offen
    s_add_u32 s63, s81, 21504
    buffer_load_dwordx4 v[52:55], v2, s[4:7], s63 offen
    s_add_u32 s63, s81, 22528
    buffer_load_dwordx4 v[56:59], v2, s[4:7], s63 offen
    s_add_u32 s63, s81, 23552
    buffer_load_dwordx4 v[60:63], v2, s[4:7], s63 offen
    s_add_u32 s63, s81, 24576
    buffer_load_dwordx4 v[64:67], v2, s[4:7], s63 offen
    s_add_u32 s63, s81, 25600
    buffer_load_dwordx4 v[68:71], v2, s[4:7], s63 offen
    s_add_u32 s63, s81, 26624
    buffer_load_dwordx4 v[72:75], v2, s[4:7], s63 offen
    s_add_u32 s63, s81, 27648
    buffer_load_dwordx4 v[76:79], v2, s[4:7], s63 offen
    s_add_u32 s63, s81, 28672
    buffer_load_dwordx4 v[80:83], v2, s[4:7], s63 offen
    s_add_u32 s63, s81, 29696
    buffer_load_dwordx4 v[84:87], v2, s[4:7], s63 offen
    s_add_u32 s63, s81, 30720
    buffer_load_dwordx4 v[88:91], v2, s[4:7], s63 offen
    s_add_u32 s63, s81, 31744
    buffer_load_dwordx4 v[92:95], v2, s[4:7], s63 offen
    s_waitcnt vmcnt(12)
    v_lshlrev_b32 v144, 16, v32
    v_and_b32 v145, s77, v32
    v_mul_f32 v144, v144, v132
    v_mul_f32 v145, v145, v133
    v_cvt_pk_bf16_f32 v146, v144, v145
    v_lshlrev_b32 v144, 16, v146
    v_and_b32 v145, s77, v146
    v_add_f32 v147, v144, v145
    v_lshlrev_b32 v144, 16, v33
    v_and_b32 v145, s77, v33
    v_mul_f32 v144, v144, v134
    v_mul_f32 v145, v145, v135
    v_cvt_pk_bf16_f32 v146, v144, v145
    v_lshlrev_b32 v144, 16, v146
    v_and_b32 v145, s77, v146
    v_add_f32 v144, v144, v145
    v_add_f32 v147, v147, v144
    v_lshlrev_b32 v144, 16, v34
    v_and_b32 v145, s77, v34
    v_mul_f32 v144, v144, v136
    v_mul_f32 v145, v145, v137
    v_cvt_pk_bf16_f32 v146, v144, v145
    v_lshlrev_b32 v144, 16, v146
    v_and_b32 v145, s77, v146
    v_add_f32 v144, v144, v145
    v_add_f32 v147, v147, v144
    v_lshlrev_b32 v144, 16, v35
    v_and_b32 v145, s77, v35
    v_mul_f32 v144, v144, v138
    v_mul_f32 v145, v145, v139
    v_cvt_pk_bf16_f32 v146, v144, v145
    v_lshlrev_b32 v144, 16, v146
    v_and_b32 v145, s77, v146
    v_add_f32 v144, v144, v145
    v_add_f32 v147, v147, v144
    v_lshlrev_b32 v148, 16, v36
    v_and_b32 v149, s77, v36
    v_mul_f32 v148, v148, v132
    v_mul_f32 v149, v149, v133
    v_cvt_pk_bf16_f32 v150, v148, v149
    v_lshlrev_b32 v148, 16, v150
    v_and_b32 v149, s77, v150
    v_add_f32 v151, v148, v149
    v_lshlrev_b32 v148, 16, v37
    v_and_b32 v149, s77, v37
    v_mul_f32 v148, v148, v134
    v_mul_f32 v149, v149, v135
    v_cvt_pk_bf16_f32 v150, v148, v149
    v_lshlrev_b32 v148, 16, v150
    v_and_b32 v149, s77, v150
    v_add_f32 v148, v148, v149
    v_add_f32 v151, v151, v148
    v_lshlrev_b32 v148, 16, v38
    v_and_b32 v149, s77, v38
    v_mul_f32 v148, v148, v136
    v_mul_f32 v149, v149, v137
    v_cvt_pk_bf16_f32 v150, v148, v149
    v_lshlrev_b32 v148, 16, v150
    v_and_b32 v149, s77, v150
    v_add_f32 v148, v148, v149
    v_add_f32 v151, v151, v148
    v_lshlrev_b32 v148, 16, v39
    v_and_b32 v149, s77, v39
    v_mul_f32 v148, v148, v138
    v_mul_f32 v149, v149, v139
    v_cvt_pk_bf16_f32 v150, v148, v149
    v_lshlrev_b32 v148, 16, v150
    v_and_b32 v149, s77, v150
    v_add_f32 v148, v148, v149
    v_add_f32 v151, v151, v148
    v_lshlrev_b32 v152, 16, v40
    v_and_b32 v153, s77, v40
    v_mul_f32 v152, v152, v132
    v_mul_f32 v153, v153, v133
    v_cvt_pk_bf16_f32 v154, v152, v153
    v_lshlrev_b32 v152, 16, v154
    v_and_b32 v153, s77, v154
    v_add_f32 v155, v152, v153
    v_lshlrev_b32 v152, 16, v41
    v_and_b32 v153, s77, v41
    v_mul_f32 v152, v152, v134
    v_mul_f32 v153, v153, v135
    v_cvt_pk_bf16_f32 v154, v152, v153
    v_lshlrev_b32 v152, 16, v154
    v_and_b32 v153, s77, v154
    v_add_f32 v152, v152, v153
    v_add_f32 v155, v155, v152
    v_lshlrev_b32 v152, 16, v42
    v_and_b32 v153, s77, v42
    v_mul_f32 v152, v152, v136
    v_mul_f32 v153, v153, v137
    v_cvt_pk_bf16_f32 v154, v152, v153
    v_lshlrev_b32 v152, 16, v154
    v_and_b32 v153, s77, v154
    v_add_f32 v152, v152, v153
    v_add_f32 v155, v155, v152
    v_lshlrev_b32 v152, 16, v43
    v_and_b32 v153, s77, v43
    v_mul_f32 v152, v152, v138
    v_mul_f32 v153, v153, v139
    v_cvt_pk_bf16_f32 v154, v152, v153
    v_lshlrev_b32 v152, 16, v154
    v_and_b32 v153, s77, v154
    v_add_f32 v152, v152, v153
    v_add_f32 v155, v155, v152
    v_lshlrev_b32 v156, 16, v44
    v_and_b32 v157, s77, v44
    v_mul_f32 v156, v156, v132
    v_mul_f32 v157, v157, v133
    v_cvt_pk_bf16_f32 v158, v156, v157
    v_lshlrev_b32 v156, 16, v158
    v_and_b32 v157, s77, v158
    v_add_f32 v159, v156, v157
    v_lshlrev_b32 v156, 16, v45
    v_and_b32 v157, s77, v45
    v_mul_f32 v156, v156, v134
    v_mul_f32 v157, v157, v135
    v_cvt_pk_bf16_f32 v158, v156, v157
    v_lshlrev_b32 v156, 16, v158
    v_and_b32 v157, s77, v158
    v_add_f32 v156, v156, v157
    v_add_f32 v159, v159, v156
    v_lshlrev_b32 v156, 16, v46
    v_and_b32 v157, s77, v46
    v_mul_f32 v156, v156, v136
    v_mul_f32 v157, v157, v137
    v_cvt_pk_bf16_f32 v158, v156, v157
    v_lshlrev_b32 v156, 16, v158
    v_and_b32 v157, s77, v158
    v_add_f32 v156, v156, v157
    v_add_f32 v159, v159, v156
    v_lshlrev_b32 v156, 16, v47
    v_and_b32 v157, s77, v47
    v_mul_f32 v156, v156, v138
    v_mul_f32 v157, v157, v139
    v_cvt_pk_bf16_f32 v158, v156, v157
    v_lshlrev_b32 v156, 16, v158
    v_and_b32 v157, s77, v158
    v_add_f32 v156, v156, v157
    v_add_f32 v159, v159, v156
    v_add_f32_dpp v147, v147, v147 row_shr:1 row_mask:0xf bank_mask:0xf bound_ctrl:0
    v_add_f32_dpp v151, v151, v151 row_shr:1 row_mask:0xf bank_mask:0xf bound_ctrl:0
    v_add_f32_dpp v155, v155, v155 row_shr:1 row_mask:0xf bank_mask:0xf bound_ctrl:0
    v_add_f32_dpp v159, v159, v159 row_shr:1 row_mask:0xf bank_mask:0xf bound_ctrl:0
    v_add_f32_dpp v147, v147, v147 row_shr:2 row_mask:0xf bank_mask:0xf bound_ctrl:0
    v_add_f32_dpp v151, v151, v151 row_shr:2 row_mask:0xf bank_mask:0xf bound_ctrl:0
    v_add_f32_dpp v155, v155, v155 row_shr:2 row_mask:0xf bank_mask:0xf bound_ctrl:0
    v_add_f32_dpp v159, v159, v159 row_shr:2 row_mask:0xf bank_mask:0xf bound_ctrl:0
    v_add_f32_dpp v147, v147, v147 row_shr:4 row_mask:0xf bank_mask:0xf bound_ctrl:0
    v_add_f32_dpp v151, v151, v151 row_shr:4 row_mask:0xf bank_mask:0xf bound_ctrl:0
    v_add_f32_dpp v155, v155, v155 row_shr:4 row_mask:0xf bank_mask:0xf bound_ctrl:0
    v_add_f32_dpp v159, v159, v159 row_shr:4 row_mask:0xf bank_mask:0xf bound_ctrl:0
    v_add_f32_dpp v147, v147, v147 row_shr:8 row_mask:0xf bank_mask:0xf bound_ctrl:0
    v_add_f32_dpp v151, v151, v151 row_shr:8 row_mask:0xf bank_mask:0xf bound_ctrl:0
    v_add_f32_dpp v155, v155, v155 row_shr:8 row_mask:0xf bank_mask:0xf bound_ctrl:0
    v_add_f32_dpp v159, v159, v159 row_shr:8 row_mask:0xf bank_mask:0xf bound_ctrl:0
    v_add_f32_dpp v147, v147, v147 row_bcast:15 row_mask:0xa bank_mask:0xf
    v_add_f32_dpp v151, v151, v151 row_bcast:15 row_mask:0xa bank_mask:0xf
    v_add_f32_dpp v155, v155, v155 row_bcast:15 row_mask:0xa bank_mask:0xf
    v_add_f32_dpp v159, v159, v159 row_bcast:15 row_mask:0xa bank_mask:0xf
    v_add_f32_dpp v147, v147, v147 row_bcast:31 row_mask:0xc bank_mask:0xf
    v_add_f32_dpp v151, v151, v151 row_bcast:31 row_mask:0xc bank_mask:0xf
    v_add_f32_dpp v155, v155, v155 row_bcast:31 row_mask:0xc bank_mask:0xf
    v_add_f32_dpp v159, v159, v159 row_bcast:31 row_mask:0xc bank_mask:0xf
    v_readlane_b32 s64, v147, 63
    v_readlane_b32 s65, v151, 63
    v_readlane_b32 s66, v155, 63
    v_readlane_b32 s67, v159, 63
    s_nop 0
    v_writelane_b32 v140, s64, 16
    v_writelane_b32 v140, s65, 17
    v_writelane_b32 v140, s66, 18
    v_writelane_b32 v140, s67, 19
    s_waitcnt vmcnt(8)
    v_lshlrev_b32 v144, 16, v48
    v_and_b32 v145, s77, v48
    v_mul_f32 v144, v144, v132
    v_mul_f32 v145, v145, v133
    v_cvt_pk_bf16_f32 v146, v144, v145
    v_lshlrev_b32 v144, 16, v146
    v_and_b32 v145, s77, v146
    v_add_f32 v147, v144, v145
    v_lshlrev_b32 v144, 16, v49
    v_and_b32 v145, s77, v49
    v_mul_f32 v144, v144, v134
    v_mul_f32 v145, v145, v135
    v_cvt_pk_bf16_f32 v146, v144, v145
    v_lshlrev_b32 v144, 16, v146
    v_and_b32 v145, s77, v146
    v_add_f32 v144, v144, v145
    v_add_f32 v147, v147, v144
    v_lshlrev_b32 v144, 16, v50
    v_and_b32 v145, s77, v50
    v_mul_f32 v144, v144, v136
    v_mul_f32 v145, v145, v137
    v_cvt_pk_bf16_f32 v146, v144, v145
    v_lshlrev_b32 v144, 16, v146
    v_and_b32 v145, s77, v146
    v_add_f32 v144, v144, v145
    v_add_f32 v147, v147, v144
    v_lshlrev_b32 v144, 16, v51
    v_and_b32 v145, s77, v51
    v_mul_f32 v144, v144, v138
    v_mul_f32 v145, v145, v139
    v_cvt_pk_bf16_f32 v146, v144, v145
    v_lshlrev_b32 v144, 16, v146
    v_and_b32 v145, s77, v146
    v_add_f32 v144, v144, v145
    v_add_f32 v147, v147, v144
    v_lshlrev_b32 v148, 16, v52
    v_and_b32 v149, s77, v52
    v_mul_f32 v148, v148, v132
    v_mul_f32 v149, v149, v133
    v_cvt_pk_bf16_f32 v150, v148, v149
    v_lshlrev_b32 v148, 16, v150
    v_and_b32 v149, s77, v150
    v_add_f32 v151, v148, v149
    v_lshlrev_b32 v148, 16, v53
    v_and_b32 v149, s77, v53
    v_mul_f32 v148, v148, v134
    v_mul_f32 v149, v149, v135
    v_cvt_pk_bf16_f32 v150, v148, v149
    v_lshlrev_b32 v148, 16, v150
    v_and_b32 v149, s77, v150
    v_add_f32 v148, v148, v149
    v_add_f32 v151, v151, v148
    v_lshlrev_b32 v148, 16, v54
    v_and_b32 v149, s77, v54
    v_mul_f32 v148, v148, v136
    v_mul_f32 v149, v149, v137
    v_cvt_pk_bf16_f32 v150, v148, v149
    v_lshlrev_b32 v148, 16, v150
    v_and_b32 v149, s77, v150
    v_add_f32 v148, v148, v149
    v_add_f32 v151, v151, v148
    v_lshlrev_b32 v148, 16, v55
    v_and_b32 v149, s77, v55
    v_mul_f32 v148, v148, v138
    v_mul_f32 v149, v149, v139
    v_cvt_pk_bf16_f32 v150, v148, v149
    v_lshlrev_b32 v148, 16, v150
    v_and_b32 v149, s77, v150
    v_add_f32 v148, v148, v149
    v_add_f32 v151, v151, v148
    v_lshlrev_b32 v152, 16, v56
    v_and_b32 v153, s77, v56
    v_mul_f32 v152, v152, v132
    v_mul_f32 v153, v153, v133
    v_cvt_pk_bf16_f32 v154, v152, v153
    v_lshlrev_b32 v152, 16, v154
    v_and_b32 v153, s77, v154
    v_add_f32 v155, v152, v153
    v_lshlrev_b32 v152, 16, v57
    v_and_b32 v153, s77, v57
    v_mul_f32 v152, v152, v134
    v_mul_f32 v153, v153, v135
    v_cvt_pk_bf16_f32 v154, v152, v153
    v_lshlrev_b32 v152, 16, v154
    v_and_b32 v153, s77, v154
    v_add_f32 v152, v152, v153
    v_add_f32 v155, v155, v152
    v_lshlrev_b32 v152, 16, v58
    v_and_b32 v153, s77, v58
    v_mul_f32 v152, v152, v136
    v_mul_f32 v153, v153, v137
    v_cvt_pk_bf16_f32 v154, v152, v153
    v_lshlrev_b32 v152, 16, v154
    v_and_b32 v153, s77, v154
    v_add_f32 v152, v152, v153
    v_add_f32 v155, v155, v152
    v_lshlrev_b32 v152, 16, v59
    v_and_b32 v153, s77, v59
    v_mul_f32 v152, v152, v138
    v_mul_f32 v153, v153, v139
    v_cvt_pk_bf16_f32 v154, v152, v153
    v_lshlrev_b32 v152, 16, v154
    v_and_b32 v153, s77, v154
    v_add_f32 v152, v152, v153
    v_add_f32 v155, v155, v152
    v_lshlrev_b32 v156, 16, v60
    v_and_b32 v157, s77, v60
    v_mul_f32 v156, v156, v132
    v_mul_f32 v157, v157, v133
    v_cvt_pk_bf16_f32 v158, v156, v157
    v_lshlrev_b32 v156, 16, v158
    v_and_b32 v157, s77, v158
    v_add_f32 v159, v156, v157
    v_lshlrev_b32 v156, 16, v61
    v_and_b32 v157, s77, v61
    v_mul_f32 v156, v156, v134
    v_mul_f32 v157, v157, v135
    v_cvt_pk_bf16_f32 v158, v156, v157
    v_lshlrev_b32 v156, 16, v158
    v_and_b32 v157, s77, v158
    v_add_f32 v156, v156, v157
    v_add_f32 v159, v159, v156
    v_lshlrev_b32 v156, 16, v62
    v_and_b32 v157, s77, v62
    v_mul_f32 v156, v156, v136
    v_mul_f32 v157, v157, v137
    v_cvt_pk_bf16_f32 v158, v156, v157
    v_lshlrev_b32 v156, 16, v158
    v_and_b32 v157, s77, v158
    v_add_f32 v156, v156, v157
    v_add_f32 v159, v159, v156
    v_lshlrev_b32 v156, 16, v63
    v_and_b32 v157, s77, v63
    v_mul_f32 v156, v156, v138
    v_mul_f32 v157, v157, v139
    v_cvt_pk_bf16_f32 v158, v156, v157
    v_lshlrev_b32 v156, 16, v158
    v_and_b32 v157, s77, v158
    v_add_f32 v156, v156, v157
    v_add_f32 v159, v159, v156
    v_add_f32_dpp v147, v147, v147 row_shr:1 row_mask:0xf bank_mask:0xf bound_ctrl:0
    v_add_f32_dpp v151, v151, v151 row_shr:1 row_mask:0xf bank_mask:0xf bound_ctrl:0
    v_add_f32_dpp v155, v155, v155 row_shr:1 row_mask:0xf bank_mask:0xf bound_ctrl:0
    v_add_f32_dpp v159, v159, v159 row_shr:1 row_mask:0xf bank_mask:0xf bound_ctrl:0
    v_add_f32_dpp v147, v147, v147 row_shr:2 row_mask:0xf bank_mask:0xf bound_ctrl:0
    v_add_f32_dpp v151, v151, v151 row_shr:2 row_mask:0xf bank_mask:0xf bound_ctrl:0
    v_add_f32_dpp v155, v155, v155 row_shr:2 row_mask:0xf bank_mask:0xf bound_ctrl:0
    v_add_f32_dpp v159, v159, v159 row_shr:2 row_mask:0xf bank_mask:0xf bound_ctrl:0
    v_add_f32_dpp v147, v147, v147 row_shr:4 row_mask:0xf bank_mask:0xf bound_ctrl:0
    v_add_f32_dpp v151, v151, v151 row_shr:4 row_mask:0xf bank_mask:0xf bound_ctrl:0
    v_add_f32_dpp v155, v155, v155 row_shr:4 row_mask:0xf bank_mask:0xf bound_ctrl:0
    v_add_f32_dpp v159, v159, v159 row_shr:4 row_mask:0xf bank_mask:0xf bound_ctrl:0
    v_add_f32_dpp v147, v147, v147 row_shr:8 row_mask:0xf bank_mask:0xf bound_ctrl:0
    v_add_f32_dpp v151, v151, v151 row_shr:8 row_mask:0xf bank_mask:0xf bound_ctrl:0
    v_add_f32_dpp v155, v155, v155 row_shr:8 row_mask:0xf bank_mask:0xf bound_ctrl:0
    v_add_f32_dpp v159, v159, v159 row_shr:8 row_mask:0xf bank_mask:0xf bound_ctrl:0
    v_add_f32_dpp v147, v147, v147 row_bcast:15 row_mask:0xa bank_mask:0xf
    v_add_f32_dpp v151, v151, v151 row_bcast:15 row_mask:0xa bank_mask:0xf
    v_add_f32_dpp v155, v155, v155 row_bcast:15 row_mask:0xa bank_mask:0xf
    v_add_f32_dpp v159, v159, v159 row_bcast:15 row_mask:0xa bank_mask:0xf
    v_add_f32_dpp v147, v147, v147 row_bcast:31 row_mask:0xc bank_mask:0xf
    v_add_f32_dpp v151, v151, v151 row_bcast:31 row_mask:0xc bank_mask:0xf
    v_add_f32_dpp v155, v155, v155 row_bcast:31 row_mask:0xc bank_mask:0xf
    v_add_f32_dpp v159, v159, v159 row_bcast:31 row_mask:0xc bank_mask:0xf
    v_readlane_b32 s64, v147, 63
    v_readlane_b32 s65, v151, 63
    v_readlane_b32 s66, v155, 63
    v_readlane_b32 s67, v159, 63
    s_nop 0
    v_writelane_b32 v140, s64, 20
    v_writelane_b32 v140, s65, 21
    v_writelane_b32 v140, s66, 22
    v_writelane_b32 v140, s67, 23
    s_waitcnt vmcnt(4)
    v_lshlrev_b32 v144, 16, v64
    v_and_b32 v145, s77, v64
    v_mul_f32 v144, v144, v132
    v_mul_f32 v145, v145, v133
    v_cvt_pk_bf16_f32 v146, v144, v145
    v_lshlrev_b32 v144, 16, v146
    v_and_b32 v145, s77, v146
    v_add_f32 v147, v144, v145
    v_lshlrev_b32 v144, 16, v65
    v_and_b32 v145, s77, v65
    v_mul_f32 v144, v144, v134
    v_mul_f32 v145, v145, v135
    v_cvt_pk_bf16_f32 v146, v144, v145
    v_lshlrev_b32 v144, 16, v146
    v_and_b32 v145, s77, v146
    v_add_f32 v144, v144, v145
    v_add_f32 v147, v147, v144
    v_lshlrev_b32 v144, 16, v66
    v_and_b32 v145, s77, v66
    v_mul_f32 v144, v144, v136
    v_mul_f32 v145, v145, v137
    v_cvt_pk_bf16_f32 v146, v144, v145
    v_lshlrev_b32 v144, 16, v146
    v_and_b32 v145, s77, v146
    v_add_f32 v144, v144, v145
    v_add_f32 v147, v147, v144
    v_lshlrev_b32 v144, 16, v67
    v_and_b32 v145, s77, v67
    v_mul_f32 v144, v144, v138
    v_mul_f32 v145, v145, v139
    v_cvt_pk_bf16_f32 v146, v144, v145
    v_lshlrev_b32 v144, 16, v146
    v_and_b32 v145, s77, v146
    v_add_f32 v144, v144, v145
    v_add_f32 v147, v147, v144
    v_lshlrev_b32 v148, 16, v68
    v_and_b32 v149, s77, v68
    v_mul_f32 v148, v148, v132
    v_mul_f32 v149, v149, v133
    v_cvt_pk_bf16_f32 v150, v148, v149
    v_lshlrev_b32 v148, 16, v150
    v_and_b32 v149, s77, v150
    v_add_f32 v151, v148, v149
    v_lshlrev_b32 v148, 16, v69
    v_and_b32 v149, s77, v69
    v_mul_f32 v148, v148, v134
    v_mul_f32 v149, v149, v135
    v_cvt_pk_bf16_f32 v150, v148, v149
    v_lshlrev_b32 v148, 16, v150
    v_and_b32 v149, s77, v150
    v_add_f32 v148, v148, v149
    v_add_f32 v151, v151, v148
    v_lshlrev_b32 v148, 16, v70
    v_and_b32 v149, s77, v70
    v_mul_f32 v148, v148, v136
    v_mul_f32 v149, v149, v137
    v_cvt_pk_bf16_f32 v150, v148, v149
    v_lshlrev_b32 v148, 16, v150
    v_and_b32 v149, s77, v150
    v_add_f32 v148, v148, v149
    v_add_f32 v151, v151, v148
    v_lshlrev_b32 v148, 16, v71
    v_and_b32 v149, s77, v71
    v_mul_f32 v148, v148, v138
    v_mul_f32 v149, v149, v139
    v_cvt_pk_bf16_f32 v150, v148, v149
    v_lshlrev_b32 v148, 16, v150
    v_and_b32 v149, s77, v150
    v_add_f32 v148, v148, v149
    v_add_f32 v151, v151, v148
    v_lshlrev_b32 v152, 16, v72
    v_and_b32 v153, s77, v72
    v_mul_f32 v152, v152, v132
    v_mul_f32 v153, v153, v133
    v_cvt_pk_bf16_f32 v154, v152, v153
    v_lshlrev_b32 v152, 16, v154
    v_and_b32 v153, s77, v154
    v_add_f32 v155, v152, v153
    v_lshlrev_b32 v152, 16, v73
    v_and_b32 v153, s77, v73
    v_mul_f32 v152, v152, v134
    v_mul_f32 v153, v153, v135
    v_cvt_pk_bf16_f32 v154, v152, v153
    v_lshlrev_b32 v152, 16, v154
    v_and_b32 v153, s77, v154
    v_add_f32 v152, v152, v153
    v_add_f32 v155, v155, v152
    v_lshlrev_b32 v152, 16, v74
    v_and_b32 v153, s77, v74
    v_mul_f32 v152, v152, v136
    v_mul_f32 v153, v153, v137
    v_cvt_pk_bf16_f32 v154, v152, v153
    v_lshlrev_b32 v152, 16, v154
    v_and_b32 v153, s77, v154
    v_add_f32 v152, v152, v153
    v_add_f32 v155, v155, v152
    v_lshlrev_b32 v152, 16, v75
    v_and_b32 v153, s77, v75
    v_mul_f32 v152, v152, v138
    v_mul_f32 v153, v153, v139
    v_cvt_pk_bf16_f32 v154, v152, v153
    v_lshlrev_b32 v152, 16, v154
    v_and_b32 v153, s77, v154
    v_add_f32 v152, v152, v153
    v_add_f32 v155, v155, v152
    v_lshlrev_b32 v156, 16, v76
    v_and_b32 v157, s77, v76
    v_mul_f32 v156, v156, v132
    v_mul_f32 v157, v157, v133
    v_cvt_pk_bf16_f32 v158, v156, v157
    v_lshlrev_b32 v156, 16, v158
    v_and_b32 v157, s77, v158
    v_add_f32 v159, v156, v157
    v_lshlrev_b32 v156, 16, v77
    v_and_b32 v157, s77, v77
    v_mul_f32 v156, v156, v134
    v_mul_f32 v157, v157, v135
    v_cvt_pk_bf16_f32 v158, v156, v157
    v_lshlrev_b32 v156, 16, v158
    v_and_b32 v157, s77, v158
    v_add_f32 v156, v156, v157
    v_add_f32 v159, v159, v156
    v_lshlrev_b32 v156, 16, v78
    v_and_b32 v157, s77, v78
    v_mul_f32 v156, v156, v136
    v_mul_f32 v157, v157, v137
    v_cvt_pk_bf16_f32 v158, v156, v157
    v_lshlrev_b32 v156, 16, v158
    v_and_b32 v157, s77, v158
    v_add_f32 v156, v156, v157
    v_add_f32 v159, v159, v156
    v_lshlrev_b32 v156, 16, v79
    v_and_b32 v157, s77, v79
    v_mul_f32 v156, v156, v138
    v_mul_f32 v157, v157, v139
    v_cvt_pk_bf16_f32 v158, v156, v157
    v_lshlrev_b32 v156, 16, v158
    v_and_b32 v157, s77, v158
    v_add_f32 v156, v156, v157
    v_add_f32 v159, v159, v156
    v_add_f32_dpp v147, v147, v147 row_shr:1 row_mask:0xf bank_mask:0xf bound_ctrl:0
    v_add_f32_dpp v151, v151, v151 row_shr:1 row_mask:0xf bank_mask:0xf bound_ctrl:0
    v_add_f32_dpp v155, v155, v155 row_shr:1 row_mask:0xf bank_mask:0xf bound_ctrl:0
    v_add_f32_dpp v159, v159, v159 row_shr:1 row_mask:0xf bank_mask:0xf bound_ctrl:0
    v_add_f32_dpp v147, v147, v147 row_shr:2 row_mask:0xf bank_mask:0xf bound_ctrl:0
    v_add_f32_dpp v151, v151, v151 row_shr:2 row_mask:0xf bank_mask:0xf bound_ctrl:0
    v_add_f32_dpp v155, v155, v155 row_shr:2 row_mask:0xf bank_mask:0xf bound_ctrl:0
    v_add_f32_dpp v159, v159, v159 row_shr:2 row_mask:0xf bank_mask:0xf bound_ctrl:0
    v_add_f32_dpp v147, v147, v147 row_shr:4 row_mask:0xf bank_mask:0xf bound_ctrl:0
    v_add_f32_dpp v151, v151, v151 row_shr:4 row_mask:0xf bank_mask:0xf bound_ctrl:0
    v_add_f32_dpp v155, v155, v155 row_shr:4 row_mask:0xf bank_mask:0xf bound_ctrl:0
    v_add_f32_dpp v159, v159, v159 row_shr:4 row_mask:0xf bank_mask:0xf bound_ctrl:0
    v_add_f32_dpp v147, v147, v147 row_shr:8 row_mask:0xf bank_mask:0xf bound_ctrl:0
    v_add_f32_dpp v151, v151, v151 row_shr:8 row_mask:0xf bank_mask:0xf bound_ctrl:0
    v_add_f32_dpp v155, v155, v155 row_shr:8 row_mask:0xf bank_mask:0xf bound_ctrl:0
    v_add_f32_dpp v159, v159, v159 row_shr:8 row_mask:0xf bank_mask:0xf bound_ctrl:0
    v_add_f32_dpp v147, v147, v147 row_bcast:15 row_mask:0xa bank_mask:0xf
    v_add_f32_dpp v151, v151, v151 row_bcast:15 row_mask:0xa bank_mask:0xf
    v_add_f32_dpp v155, v155, v155 row_bcast:15 row_mask:0xa bank_mask:0xf
    v_add_f32_dpp v159, v159, v159 row_bcast:15 row_mask:0xa bank_mask:0xf
    v_add_f32_dpp v147, v147, v147 row_bcast:31 row_mask:0xc bank_mask:0xf
    v_add_f32_dpp v151, v151, v151 row_bcast:31 row_mask:0xc bank_mask:0xf
    v_add_f32_dpp v155, v155, v155 row_bcast:31 row_mask:0xc bank_mask:0xf
    v_add_f32_dpp v159, v159, v159 row_bcast:31 row_mask:0xc bank_mask:0xf
    v_readlane_b32 s64, v147, 63
    v_readlane_b32 s65, v151, 63
    v_readlane_b32 s66, v155, 63
    v_readlane_b32 s67, v159, 63
    s_nop 0
    v_writelane_b32 v140, s64, 24
    v_writelane_b32 v140, s65, 25
    v_writelane_b32 v140, s66, 26
    v_writelane_b32 v140, s67, 27
    s_waitcnt vmcnt(0)
    v_lshlrev_b32 v144, 16, v80
    v_and_b32 v145, s77, v80
    v_mul_f32 v144, v144, v132
    v_mul_f32 v145, v145, v133
    v_cvt_pk_bf16_f32 v146, v144, v145
    v_lshlrev_b32 v144, 16, v146
    v_and_b32 v145, s77, v146
    v_add_f32 v147, v144, v145
    v_lshlrev_b32 v144, 16, v81
    v_and_b32 v145, s77, v81
    v_mul_f32 v144, v144, v134
    v_mul_f32 v145, v145, v135
    v_cvt_pk_bf16_f32 v146, v144, v145
    v_lshlrev_b32 v144, 16, v146
    v_and_b32 v145, s77, v146
    v_add_f32 v144, v144, v145
    v_add_f32 v147, v147, v144
    v_lshlrev_b32 v144, 16, v82
    v_and_b32 v145, s77, v82
    v_mul_f32 v144, v144, v136
    v_mul_f32 v145, v145, v137
    v_cvt_pk_bf16_f32 v146, v144, v145
    v_lshlrev_b32 v144, 16, v146
    v_and_b32 v145, s77, v146
    v_add_f32 v144, v144, v145
    v_add_f32 v147, v147, v144
    v_lshlrev_b32 v144, 16, v83
    v_and_b32 v145, s77, v83
    v_mul_f32 v144, v144, v138
    v_mul_f32 v145, v145, v139
    v_cvt_pk_bf16_f32 v146, v144, v145
    v_lshlrev_b32 v144, 16, v146
    v_and_b32 v145, s77, v146
    v_add_f32 v144, v144, v145
    v_add_f32 v147, v147, v144
    v_lshlrev_b32 v148, 16, v84
    v_and_b32 v149, s77, v84
    v_mul_f32 v148, v148, v132
    v_mul_f32 v149, v149, v133
    v_cvt_pk_bf16_f32 v150, v148, v149
    v_lshlrev_b32 v148, 16, v150
    v_and_b32 v149, s77, v150
    v_add_f32 v151, v148, v149
    v_lshlrev_b32 v148, 16, v85
    v_and_b32 v149, s77, v85
    v_mul_f32 v148, v148, v134
    v_mul_f32 v149, v149, v135
    v_cvt_pk_bf16_f32 v150, v148, v149
    v_lshlrev_b32 v148, 16, v150
    v_and_b32 v149, s77, v150
    v_add_f32 v148, v148, v149
    v_add_f32 v151, v151, v148
    v_lshlrev_b32 v148, 16, v86
    v_and_b32 v149, s77, v86
    v_mul_f32 v148, v148, v136
    v_mul_f32 v149, v149, v137
    v_cvt_pk_bf16_f32 v150, v148, v149
    v_lshlrev_b32 v148, 16, v150
    v_and_b32 v149, s77, v150
    v_add_f32 v148, v148, v149
    v_add_f32 v151, v151, v148
    v_lshlrev_b32 v148, 16, v87
    v_and_b32 v149, s77, v87
    v_mul_f32 v148, v148, v138
    v_mul_f32 v149, v149, v139
    v_cvt_pk_bf16_f32 v150, v148, v149
    v_lshlrev_b32 v148, 16, v150
    v_and_b32 v149, s77, v150
    v_add_f32 v148, v148, v149
    v_add_f32 v151, v151, v148
    v_lshlrev_b32 v152, 16, v88
    v_and_b32 v153, s77, v88
    v_mul_f32 v152, v152, v132
    v_mul_f32 v153, v153, v133
    v_cvt_pk_bf16_f32 v154, v152, v153
    v_lshlrev_b32 v152, 16, v154
    v_and_b32 v153, s77, v154
    v_add_f32 v155, v152, v153
    v_lshlrev_b32 v152, 16, v89
    v_and_b32 v153, s77, v89
    v_mul_f32 v152, v152, v134
    v_mul_f32 v153, v153, v135
    v_cvt_pk_bf16_f32 v154, v152, v153
    v_lshlrev_b32 v152, 16, v154
    v_and_b32 v153, s77, v154
    v_add_f32 v152, v152, v153
    v_add_f32 v155, v155, v152
    v_lshlrev_b32 v152, 16, v90
    v_and_b32 v153, s77, v90
    v_mul_f32 v152, v152, v136
    v_mul_f32 v153, v153, v137
    v_cvt_pk_bf16_f32 v154, v152, v153
    v_lshlrev_b32 v152, 16, v154
    v_and_b32 v153, s77, v154
    v_add_f32 v152, v152, v153
    v_add_f32 v155, v155, v152
    v_lshlrev_b32 v152, 16, v91
    v_and_b32 v153, s77, v91
    v_mul_f32 v152, v152, v138
    v_mul_f32 v153, v153, v139
    v_cvt_pk_bf16_f32 v154, v152, v153
    v_lshlrev_b32 v152, 16, v154
    v_and_b32 v153, s77, v154
    v_add_f32 v152, v152, v153
    v_add_f32 v155, v155, v152
    v_lshlrev_b32 v156, 16, v92
    v_and_b32 v157, s77, v92
    v_mul_f32 v156, v156, v132
    v_mul_f32 v157, v157, v133
    v_cvt_pk_bf16_f32 v158, v156, v157
    v_lshlrev_b32 v156, 16, v158
    v_and_b32 v157, s77, v158
    v_add_f32 v159, v156, v157
    v_lshlrev_b32 v156, 16, v93
    v_and_b32 v157, s77, v93
    v_mul_f32 v156, v156, v134
    v_mul_f32 v157, v157, v135
    v_cvt_pk_bf16_f32 v158, v156, v157
    v_lshlrev_b32 v156, 16, v158
    v_and_b32 v157, s77, v158
    v_add_f32 v156, v156, v157
    v_add_f32 v159, v159, v156
    v_lshlrev_b32 v156, 16, v94
    v_and_b32 v157, s77, v94
    v_mul_f32 v156, v156, v136
    v_mul_f32 v157, v157, v137
    v_cvt_pk_bf16_f32 v158, v156, v157
    v_lshlrev_b32 v156, 16, v158
    v_and_b32 v157, s77, v158
    v_add_f32 v156, v156, v157
    v_add_f32 v159, v159, v156
    v_lshlrev_b32 v156, 16, v95
    v_and_b32 v157, s77, v95
    v_mul_f32 v156, v156, v138
    v_mul_f32 v157, v157, v139
    v_cvt_pk_bf16_f32 v158, v156, v157
    v_lshlrev_b32 v156, 16, v158
    v_and_b32 v157, s77, v158
    v_add_f32 v156, v156, v157
    v_add_f32 v159, v159, v156
    v_add_f32_dpp v147, v147, v147 row_shr:1 row_mask:0xf bank_mask:0xf bound_ctrl:0
    v_add_f32_dpp v151, v151, v151 row_shr:1 row_mask:0xf bank_mask:0xf bound_ctrl:0
    v_add_f32_dpp v155, v155, v155 row_shr:1 row_mask:0xf bank_mask:0xf bound_ctrl:0
    v_add_f32_dpp v159, v159, v159 row_shr:1 row_mask:0xf bank_mask:0xf bound_ctrl:0
    v_add_f32_dpp v147, v147, v147 row_shr:2 row_mask:0xf bank_mask:0xf bound_ctrl:0
    v_add_f32_dpp v151, v151, v151 row_shr:2 row_mask:0xf bank_mask:0xf bound_ctrl:0
    v_add_f32_dpp v155, v155, v155 row_shr:2 row_mask:0xf bank_mask:0xf bound_ctrl:0
    v_add_f32_dpp v159, v159, v159 row_shr:2 row_mask:0xf bank_mask:0xf bound_ctrl:0
    v_add_f32_dpp v147, v147, v147 row_shr:4 row_mask:0xf bank_mask:0xf bound_ctrl:0
    v_add_f32_dpp v151, v151, v151 row_shr:4 row_mask:0xf bank_mask:0xf bound_ctrl:0
    v_add_f32_dpp v155, v155, v155 row_shr:4 row_mask:0xf bank_mask:0xf bound_ctrl:0
    v_add_f32_dpp v159, v159, v159 row_shr:4 row_mask:0xf bank_mask:0xf bound_ctrl:0
    v_add_f32_dpp v147, v147, v147 row_shr:8 row_mask:0xf bank_mask:0xf bound_ctrl:0
    v_add_f32_dpp v151, v151, v151 row_shr:8 row_mask:0xf bank_mask:0xf bound_ctrl:0
    v_add_f32_dpp v155, v155, v155 row_shr:8 row_mask:0xf bank_mask:0xf bound_ctrl:0
    v_add_f32_dpp v159, v159, v159 row_shr:8 row_mask:0xf bank_mask:0xf bound_ctrl:0
    v_add_f32_dpp v147, v147, v147 row_bcast:15 row_mask:0xa bank_mask:0xf
    v_add_f32_dpp v151, v151, v151 row_bcast:15 row_mask:0xa bank_mask:0xf
    v_add_f32_dpp v155, v155, v155 row_bcast:15 row_mask:0xa bank_mask:0xf
    v_add_f32_dpp v159, v159, v159 row_bcast:15 row_mask:0xa bank_mask:0xf
    v_add_f32_dpp v147, v147, v147 row_bcast:31 row_mask:0xc bank_mask:0xf
    v_add_f32_dpp v151, v151, v151 row_bcast:31 row_mask:0xc bank_mask:0xf
    v_add_f32_dpp v155, v155, v155 row_bcast:31 row_mask:0xc bank_mask:0xf
    v_add_f32_dpp v159, v159, v159 row_bcast:31 row_mask:0xc bank_mask:0xf
    v_readlane_b32 s64, v147, 63
    v_readlane_b32 s65, v151, 63
    v_readlane_b32 s66, v155, 63
    v_readlane_b32 s67, v159, 63
    s_nop 0
    v_writelane_b32 v140, s64, 28
    v_writelane_b32 v140, s65, 29
    v_writelane_b32 v140, s66, 30
    v_writelane_b32 v140, s67, 31
    v_cvt_pk_bf16_f32 v144, v140, v140
    v_lshlrev_b32 v144, 16, v144
    v_mul_f32 v144, 0xbfb8aa3b, v144
    v_exp_f32 v144, v144
    s_nop 0
    v_add_f32 v144, 1.0, v144
    v_rcp_f32 v144, v144
    s_nop 0
    v_cvt_pk_bf16_f32 v144, v144, v144
    v_lshlrev_b32 v144, 16, v144
    v_sub_f32 v145, 1.0, v144
    v_cvt_pk_bf16_f32 v144, v144, v145
    v_lshlrev_b32 v146, 2, v1
    s_lshl_b32 s62, s57, 9
    s_lshl_b32 s63, s56, 7
    s_add_u32 s62, s62, s63
    s_add_u32 s62, s62, 0xa00000
    s_mov_b64 exec, 0xffffffff
    buffer_store_dword v144, v146, s[44:47], s62 offen sc1
    s_mov_b64 exec, -1
    s_waitcnt vmcnt(0) lgkmcnt(0)
    s_lshl_b32 s62, s57, 4
    s_lshl_b32 s63, s56, 2
    s_add_u32 s62, s62, s63
    s_add_u32 s62, s62, 0xb0a000
    v_mov_b32 v13, s61
    v_mov_b32 v14, 0
    s_mov_b64 exec, 1
    buffer_store_dword v13, v14, s[44:47], s62 offen sc1
    s_mov_b64 exec, -1
    s_waitcnt vmcnt(0) lgkmcnt(0)
    s_branch L_c_join2
L_l_g:
    v_mov_b32 v13, 0
    s_mov_b32 s62, 0xb00000
    buffer_load_dword v24, v13, s[44:47], s62 offen sc1
    s_lshl_b32 s63, s87, 2
    buffer_load_dword v25, v13, s[52:55], s63 offen
    v_and_b32 v27, 255, v0
    s_and_b32 s63, s56, 1
    s_lshl_b32 s64, s85, 12
    s_lshl_b32 s65, s63, 2
    s_add_u32 s64, s64, s65
    s_sub_u32 s64, s64, 64
    s_mov_b32 s63, 0xaaab
    v_add_u32 v13, 0, v1
    v_mul_u32_u24 v14, s63, v13
    v_lshrrev_b32 v14, 20, v14
    v_mul_u32_u24 v15, 24, v14
    v_sub_u32 v15, v13, v15
    v_lshlrev_b32 v15, 4, v15
    v_lshl_add_u32 v15, v14, 8, v15
    v_add_u32 v32, s64, v15
    v_add_u32 v35, 2048, v32
    v_add_u32 v13, 64, v1
    v_mul_u32_u24 v14, s63, v13
    v_lshrrev_b32 v14, 20, v14
    v_mul_u32_u24 v15, 24, v14
    v_sub_u32 v15, v13, v15
    v_lshlrev_b32 v15, 4, v15
    v_lshl_add_u32 v15, v14, 8, v15
    v_add_u32 v33, s64, v15
    v_add_u32 v36, 2048, v33
    v_add_u32 v13, 128, v1
    v_mul_u32_u24 v14, s63, v13
    v_lshrrev_b32 v14, 20, v14
    v_mul_u32_u24 v15, 24, v14
    v_sub_u32 v15, v13, v15
    v_lshlrev_b32 v15, 4, v15
    v_lshl_add_u32 v15, v14, 8, v15
    v_add_u32 v34, s64, v15
    v_add_u32 v37, 2048, v34
    v_lshrrev_b32 v13, 3, v1
    v_bfe_u32 v14, v1, 4, 1
    v_lshlrev_b32 v14, 2, v14
    v_and_b32 v15, 7, v1
    v_xor_b32 v15, v15, v14
    v_lshlrev_b32 v15, 4, v15
    v_lshl_add_u32 v15, v13, 10, v15
    s_lshl_b32 s62, s60, 7
    v_add_u32 v28, s62, v15
    v_add_u32 v29, 7168, v28
    v_add_u32 v30, 14336, v28
    v_add_u32 v31, 21504, v28
    s_lshl_b32 s89, s56, 12
    s_mov_b32 s63, s89
    v_lshrrev_b32 v13, 5, v1
    v_lshlrev_b32 v13, 9, v13
    v_bfe_u32 v14, v1, 2, 2
    v_lshl_add_u32 v13, v14, 7, v13
    v_bfe_u32 v14, v1, 4, 1
    v_lshl_add_u32 v13, v14, 5, v13
    v_and_b32 v14, 3, v1
    v_lshl_add_u32 v13, v14, 3, v13
    v_bfe_u32 v14, v1, 3, 1
    v_lshl_add_u32 v13, v14, 6, v13
    v_add_u32 v10, s63, v13
    v_xor_b32 v14, 64, v13
    v_add_u32 v11, s63, v14
    s_mul_i32 s62, s56, 6144
    s_add_u32 s90, s62, 0
    s_add_u32 s91, s62, 24576
    s_add_u32 s92, s62, 49152
    s_add_u32 s93, s62, 73728
    s_cmp_eq_u32 s56, 3
    s_cselect_b32 s93, 2048, s93
    s_add_u32 s94, s62, 8192
    s_add_u32 s95, s62, 32768
    s_add_u32 s96, s62, 57344
    s_add_u32 s97, s62, 0xfffff800
    s_cmp_eq_u32 s56, 0
    s_cselect_b32 s97, 81920, s97
    s_add_u32 s98, s62, 22528
    s_add_u32 s99, s62, 47104
    s_add_u32 s100, s62, 71680
    s_mul_i32 s83, s59, 176128
    v_lshrrev_b32 v13, 3, v0
    v_and_b32 v14, 7, v0
    v_lshlrev_b32 v14, 4, v14
    v_lshl_add_u32 v13, v13, 10, v14
    s_lshl_b32 s62, s59, 16
    s_lshl_b32 s63, s60, 7
    s_add_u32 s62, s62, s63
    v_add_u32 v26, s62, v13
    s_waitcnt vmcnt(0) lgkmcnt(0)
    s_barrier
    v_readfirstlane_b32 s61, v24
    v_readfirstlane_b32 s62, v25
    s_nop 3
    s_add_u32 s61, s61, 0x9e3779b9
    s_lshl_b32 s64, s62, 16
    s_and_b32 s65, s62, 0xffff0000
    s_cmp_lt_u32 s56, 2
    s_cselect_b32 s88, s64, s65
    s_mul_i32 s70, s56, 6208
    s_add_u32 m0, s70, 123648
    s_nop 0
    buffer_load_dwordx4 v32, s[20:23], 0 offen lds
    s_add_u32 m0, s70, 124672
    s_nop 0
    buffer_load_dwordx4 v33, s[20:23], 0 offen lds
    s_add_u32 m0, s70, 125696
    s_nop 0
    buffer_load_dwordx4 v34, s[20:23], 0 offen lds
    s_add_u32 m0, s70, 126720
    s_nop 0
    buffer_load_dwordx4 v35, s[20:23], 0 offen lds
    s_add_u32 m0, s70, 127744
    s_nop 0
    buffer_load_dwordx4 v36, s[20:23], 0 offen lds
    s_add_u32 m0, s70, 128768
    s_nop 0
    buffer_load_dwordx4 v37, s[20:23], 0 offen lds
    s_lshl_b32 s70, s85, 12
    v_mov_b32 v17, 0
    buffer_load_dword v25, v17, s[20:23], s70 offen
    s_lshr_b32 s62, s56, 1
    s_and_b32 s63, s56, 1
    v_and_b32 v13, 15, v1
    v_lshrrev_b32 v14, 4, v1
    v_lshlrev_b32 v15, 2, v14
    v_sub_u32 v15, v15, v13
    v_add_u32 v15, 63, v15
    v_mul_u32_u24 v15, 80, v15
    s_mul_i32 s64, s62, 6400
    s_mul_i32 s65, s63, 160
    s_add_u32 s64, s64, s65
    s_add_u32 s64, s64, 144640
    v_add_u32 v3, s64, v15
    v_add_u32 v13, 1, v13
    v_and_b32 v5, 1, v13
    v_lshlrev_b32 v5, 4, v5
    v_bfe_u32 v15, v13, 1, 1
    v_mul_u32_u24 v15, 6208, v15
    v_and_b32 v13, 28, v13
    v_lshl_add_u32 v15, v13, 1, v15
    v_mul_u32_u24 v14, 384, v14
    v_add_u32 v15, v15, v14
    s_mul_i32 s64, s62, 12416
    s_lshl_b32 s65, s63, 7
    s_add_u32 s64, s64, s65
    s_add_u32 s64, s64, 123648
    v_add_u32 v4, s64, v15
    v_mov_b32 v13, 162336
    s_mov_b32 s86, 0
L_lw13:
    ds_read_b128 v[20:23], v13
    s_waitcnt lgkmcnt(0)
    v_and_b32 v20, v20, v21
    v_and_b32 v22, v22, v23
    v_and_b32 v20, v20, v22
    v_cmp_eq_u32 vcc, 1, v20
    s_nop 1
    s_cmp_eq_u64 vcc, -1
    s_cbranch_scc1 L_ld13
    s_add_u32 s86, s86, 1
    s_cmp_ge_u32 s86, 1600000
    s_cbranch_scc1 L_ld13
    s_sleep 1
    s_branch L_lw13
L_ld13:
    s_waitcnt lgkmcnt(0)
    v_and_b32 v19, 31, v1
    v_lshlrev_b32 v19, 4, v19
    s_lshr_b32 s72, s87, 5
    s_lshl_b32 s72, s72, 9
    s_add_u32 s72, s72, 0xb01000
    v_mov_b32 v156, 0
    v_mov_b32 v157, 0
    v_mov_b32 v158, 0
    v_mov_b32 v159, 0
    v_lshlrev_b32 v17, 4, v27
    v_add_u32 v17, 148480, v17
    v_cmp_gt_u32 vcc, 80, v27
    s_nop 0
    s_and_saveexec_b64 s[78:79], vcc
    ds_write_b128 v17, v[156:159] offset:5120
    ds_write_b128 v17, v[156:159] offset:11520
    s_mov_b64 exec, -1
    s_waitcnt vmcnt(0) lgkmcnt(0)
    s_branch L_l_join
L_fin:
L_end:
    s_endpgm
.section .rodata,"a"
.p2align 6
.amdhsa_kernel gated_mix__ssm_conv_h3__geglu_ffn__prompt_kernel
  .amdhsa_next_free_vgpr 256
  .amdhsa_next_free_sgpr 102
  .amdhsa_accum_offset 160
  .amdhsa_group_segment_fixed_size 0
  .amdhsa_kernarg_size 112
  .amdhsa_user_sgpr_count 2
  .amdhsa_user_sgpr_kernarg_segment_ptr 1
  .amdhsa_system_sgpr_workgroup_id_x 1
.end_amdhsa_kernel
```
